```python
import torch

def _softmax(x, axis=-1):
    return torch.softmax(x, dim=axis)

def _gelu(x):
    return torch.nn.functional.gelu(x, approximate='tanh')

def _silu(x):
    return torch.nn.functional.silu(x)

def _sigmoid(x):
    return torch.sigmoid(x)

def _layernorm(x, axis=-1, eps=1e-05):
    m = x.mean(dim=axis, keepdim=True)
    v = x.var(dim=axis, keepdim=True, unbiased=False)
    return (x - m) / torch.sqrt(v + eps)

def _scatter_add(tgt, idx, src, axis=0):
    return tgt.clone().index_add_(axis, idx, src)

def _segment_sum(src, seg, n):
    out = torch.zeros((n,) + src.shape[1:], dtype=src.dtype)
    return out.index_add_(0, seg, src)

def _pad(x, pw):
    flat = tuple((v for pair in reversed(pw) for v in pair))
    return torch.nn.functional.pad(x, flat)
kernel_name = 'adaLN_cond__gqa_block_cached__swiglu_ffn__decode'

def setup_inputs():

    _w = lambda a: (lambda t: t.to(torch.bfloat16) if t.is_floating_point() else t)(torch.as_tensor(a))

    def _A_setup():
        B, Sq, D = (1, 1, 448)
        Hq, Hkv, Sk, Dh = (16, 8, 32768, 256)
        assert Hq % Hkv == 0, (Hq, Hkv)
        return {'x': _w((lambda *s: torch.randn(*s, dtype=torch.bfloat16) * 0.1)(B, Sq, D)), 'k_cache': _w((lambda *s: torch.randn(*s, dtype=torch.bfloat16) * 0.8)(B, Hkv, Sk, Dh)), 'v_cache': _w((lambda *s: torch.randn(*s, dtype=torch.bfloat16) * 0.8)(B, Hkv, Sk, Dh)), 'wq': _w((lambda *s: torch.randn(*s, dtype=torch.bfloat16) * 0.8)(D, Hq * Dh) * D ** (-0.5)), 'wo': _w((lambda *s: torch.randn(*s, dtype=torch.bfloat16) * 0.8)(Hq * Dh, D) * (Hq * Dh) ** (-0.5))}
    _A_in = _A_setup()

    def _B_setup():
        B, S, D, F = (1, 1, 448, 1792)
        return {'x': _w((lambda *s: torch.randn(*s, dtype=torch.bfloat16) * 0.1)(B, S, D)), 'w_gate': _w((lambda *s: torch.randn(*s, dtype=torch.bfloat16) * 0.1)(D, F)), 'w_up': _w((lambda *s: torch.randn(*s, dtype=torch.bfloat16) * 0.1)(D, F)), 'w_down': _w((lambda *s: torch.randn(*s, dtype=torch.bfloat16) * 0.1)(F, D))}
    _B_in = _B_setup()
    return {'A_x': _A_in['x'], 'A_k_cache': _A_in['k_cache'], 'A_v_cache': _A_in['v_cache'], 'A_wq': _A_in['wq'], 'A_wo': _A_in['wo'], 'B_x': _B_in['x'], 'B_w_gate': _B_in['w_gate'], 'B_w_up': _B_in['w_up'], 'B_w_down': _B_in['w_down'], 'c': _w((lambda *s: torch.randn(*s, dtype=torch.bfloat16) * 0.4)(1, 448) * 8.0), 'w_mod': _w((lambda *s: torch.randn(*s, dtype=torch.bfloat16) * 0.4)(448, 6 * 448) * 448 ** (-0.5) * 8.0)}

def reference(A_x, A_k_cache, A_v_cache, A_wq, A_wo, B_x, B_w_gate, B_w_up, B_w_down, c, w_mod):

    def _A_ref(x, k_cache, v_cache, wq, wo):
        B, Sq, D = x.shape
        Hq, Dh = (16, 256)
        Hkv = k_cache.shape[1]
        rep = Hq // Hkv
        q = (lambda x, *d: x.permute(*d))((x @ wq).reshape(B, Sq, Hq, Dh), 0, 2, 1, 3)
        k = (lambda x, n, axis: torch.repeat_interleave(x, n, dim=axis))(k_cache, rep, axis=1)
        v = (lambda x, n, axis: torch.repeat_interleave(x, n, dim=axis))(v_cache, rep, axis=1)
        scores = torch.einsum('bhqd,bhkd->bhqk', q, k) * Dh ** (-0.5)
        p = _softmax(scores, axis=-1)
        o = torch.einsum('bhqk,bhkd->bhqd', p, v)
        return (lambda x, *d: x.permute(*d))(o, 0, 2, 1, 3).reshape(B, Sq, Hq * Dh) @ wo

    def _B_ref(x, w_gate, w_up, w_down):
        g = _silu(x @ w_gate)
        u = x @ w_up
        return g * u @ w_down
    x = A_x
    mod = (_silu(c) @ w_mod).reshape(c.shape[0], 6, 1, -1)
    sa, ca, ga, sb, cb, gb = (mod[:, 0].clone(), mod[:, 1].clone(), mod[:, 2].clone(), mod[:, 3].clone(), mod[:, 4].clone(), mod[:, 5].clone())
    h = _layernorm(x, axis=-1) * (1 + ca) + sa
    x = x + ga * _A_ref(h, A_k_cache, A_v_cache, A_wq, A_wo)
    h = _layernorm(x, axis=-1) * (1 + cb) + sb
    x = x + gb * _B_ref(h, B_w_gate, B_w_up, B_w_down)
    return x
```

```asm
; @launch grid=(256,1,1) block=(512,1,1) lds=117056
.amdgcn_target "amdgcn-amd-amdhsa--gfx950"
.text
.globl adaLN_cond__gqa_block_cached__swiglu_ffn__decode_kernel
.p2align 8
.type adaLN_cond__gqa_block_cached__swiglu_ffn__decode_kernel,@function
adaLN_cond__gqa_block_cached__swiglu_ffn__decode_kernel:
    s_cmp_ge_u32 s2, 256
    s_cbranch_scc1 L_end
    s_load_dwordx16 s[16:31], s[0:1], 0
    s_load_dwordx8 s[32:39], s[0:1], 64
    s_load_dwordx2 s[8:9], s[0:1], 104
    v_lshrrev_b32 v1, 6, v0
    v_and_b32 v3, 63, v0
    v_readfirstlane_b32 s3, v1
    s_and_b32 s4, s2, 7
    s_lshr_b32 s5, s2, 3
    s_mov_b32 s10, 0x200000
    s_mov_b32 s11, 0x20000
    s_mov_b32 s60, 0
    s_cmp_lt_u32 s3, 4
    s_cbranch_scc1 L_S
    s_setprio 3
    s_sub_u32 s12, s3, 4
    v_mov_b32 v4, 0
    v_mov_b32 v12, 0
    v_mov_b32 v13, 0
    v_mov_b32 v14, 0
    v_mov_b32 v15, 0
    ds_write_b128 v4, v[12:15] offset:0
    s_lshl_b32 s49, s5, 2
    s_add_u32 s49, s49, s12
    s_getpc_b64 s[52:53]
L_pcref:
    s_sub_u32 s52, s52, L_pcref-adaLN_cond__gqa_block_cached__swiglu_ffn__decode_kernel
    s_subb_u32 s53, s53, 0
    s_lshl_b32 s54, s49, 8
    v_lshl_add_u32 v10, v3, 2, s54
    v_min_u32 v10, L_end-adaLN_cond__gqa_block_cached__swiglu_ffn__decode_kernel, v10
    global_load_dword v11, v10, s[52:53]
    v_min_u32 v5, 55, v3
    v_lshlrev_b32 v5, 4, v5
    s_lshl_b32 s53, s49, 13
    s_lshl_b32 s54, s4, 10
    s_add_u32 s53, s53, s54
    v_lshl_add_u32 v6, v3, 4, s53
    v_add_u32 v7, 0x100000, v6
    v_add_u32 v8, 0x200000, v6
    v_add_u32 v9, 0x300000, v6
    v_lshrrev_b32 v16, 4, v3
    v_mul_u32_u24 v16, 5376, v16
    v_and_b32 v17, 15, v3
    v_lshl_add_u32 v16, v17, 4, v16
    s_mul_i32 s53, s49, 21504
    s_lshl_b32 s54, s4, 8
    s_add_u32 s53, s53, s54
    v_add_u32 v16, s53, v16
    s_mov_b32 s68, 4
    s_mov_b32 s69, 0
    s_cmp_lt_u32 s4, 7
    s_cselect_b32 s50, 2408448, 0
    s_mov_b32 s42, 3670016
    s_mov_b32 s43, 0x20000
    s_mov_b32 s51, 0x20000
    s_mov_b32 s46, 896
    s_mov_b32 s47, 0x20000
    s_lshl_b32 s13, s4, 1
    s_add_u32 s13, s13, s5
    s_sub_u32 s13, s13, 21
    s_sub_u32 s53, s5, 21
    s_cmp_lt_u32 s53, 2
    s_cselect_b32 s13, s13, 14
    s_cmp_lt_u32 s13, 14
    s_waitcnt lgkmcnt(0)
    s_cselect_b64 s[44:45], s[34:35], s[16:17]
    s_mov_b64 s[40:41], s[22:23]
    s_mov_b32 s59, s49
    s_mov_b64 s[48:49], s[36:37]
    buffer_load_dwordx4 v[24:27], v16, s[48:51], 0 offen
    buffer_load_dwordx4 v[24:27], v6, s[40:43], 0 offen
    buffer_load_dwordx4 v[24:27], v7, s[40:43], 0 offen
    buffer_load_dwordx4 v[24:27], v8, s[40:43], 0 offen
    buffer_load_dwordx4 v[24:27], v9, s[40:43], 0 offen
    buffer_load_dword v1, v4, s[8:11], 0 offen sc1
    buffer_load_dwordx4 v[20:23], v5, s[44:47], 0 offen
    s_mov_b32 s49, s59
    v_mov_b32 v230, 0
    s_cbranch_scc1 L_P1a
    v_lshlrev_b32 v6, 4, v3
    v_lshrrev_b32 v8, 5, v3
    v_and_b32 v9, 31, v3
    v_lshlrev_b32 v9, 4, v9
    v_mul_u32_u24 v7, 3584, v8
    v_add_u32 v7, v7, v9
    v_mul_u32_u24 v8, 5376, v8
    v_add_u32 v8, v8, v9
    s_sub_u32 s55, s49, 8
    s_cmp_lt_u32 s5, 21
    s_cselect_b32 s55, s49, s55
    s_sub_u32 s53, s5, 21
    s_cmp_lt_u32 s53, 2
    s_cbranch_scc1 L_pfz
    s_mul_i32 s54, s4, 458752
    s_mov_b64 s[40:41], s[24:25]
    s_mov_b32 s42, 3670016
    s_mul_i32 s53, s55, 1024
    s_add_u32 s52, s54, s53
L_pl_1:
    buffer_load_dwordx4 v[24:27], v6, s[40:43], s52 offen
    s_add_u32 s52, s52, 122880
    s_add_u32 s55, s55, 120
    s_cmp_lt_u32 s55, 448
    s_cbranch_scc1 L_pl_1
    s_sub_u32 s55, s55, 448
    s_mul_i32 s54, s4, 448
    s_and_b32 s54, s54, 0xffffff80
    s_mov_b64 s[40:41], s[28:29]
    s_mov_b32 s42, 1605632
    s_mul_i32 s53, s55, 7168
    s_add_u32 s52, s54, s53
L_pl_2:
    buffer_load_dwordx4 v[24:27], v7, s[40:43], s52 offen
    s_add_u32 s52, s52, 860160
    s_add_u32 s55, s55, 120
    s_cmp_lt_u32 s55, 224
    s_cbranch_scc1 L_pl_2
    s_sub_u32 s55, s55, 224
    s_mul_i32 s54, s4, 200704
    s_cmp_lt_u32 s5, 18
    s_cbranch_scc0 L_pfy
    s_cmp_lt_u32 s4, 7
    s_cbranch_scc0 L_pfy
    s_lshl_b32 s54, s4, 9
    s_add_u32 s54, s54, 1792
    s_sub_u32 s55, 71, s49
    s_mov_b64 s[40:41], s[36:37]
    s_mov_b32 s42, 2408448
    s_mul_i32 s53, s55, 10752
    s_add_u32 s52, s54, s53
L_pl_3:
    buffer_load_dwordx4 v[24:27], v8, s[40:43], s52 offen
    s_add_u32 s52, s52, 774144
    s_add_u32 s55, s55, 72
    s_cmp_lt_u32 s55, 224
    s_cbranch_scc1 L_pl_3
    s_sub_u32 s55, s55, 224
L_pfz:
L_pfy:
    s_barrier
    s_cmp_ge_u32 s5, 24
    s_cbranch_scc1 L_P2
    s_branch L_HE
L_S:
    v_and_b32 v0, 15, v3
    v_lshlrev_b32 v0, 4, v0
    v_bfe_u32 v4, v3, 4, 1
    v_lshl_or_b32 v0, v4, 20, v0
    v_lshrrev_b32 v4, 5, v3
    v_lshl_or_b32 v0, v4, 13, v0
    s_lshl_b32 s7, s4, 24
    s_bfe_u32 s6, s3, 0x10000
    s_lshl_b32 s6, s6, 9
    s_or_b32 s7, s7, s6
    s_bfe_u32 s6, s3, 0x10001
    s_lshl_b32 s6, s6, 15
    s_or_b32 s7, s7, s6
    s_bfe_u32 s6, s5, 0x10000
    s_lshl_b32 s6, s6, 10
    s_or_b32 s7, s7, s6
    s_bfe_u32 s6, s5, 0x10001
    s_lshl_b32 s6, s6, 14
    s_or_b32 s7, s7, s6
    s_bfe_u32 s6, s5, 0x10002
    s_lshl_b32 s6, s6, 17
    s_or_b32 s7, s7, s6
    s_bfe_u32 s6, s5, 0x10003
    s_lshl_b32 s6, s6, 19
    s_or_b32 s7, s7, s6
    s_bfe_u32 s6, s5, 0x10004
    s_lshl_b32 s6, s6, 21
    s_or_b32 s7, s7, s6
    s_bfe_u32 s6, s4, 0x10000
    s_lshl_b32 s6, s6, 16
    s_or_b32 s7, s7, s6
    s_bfe_u32 s6, s4, 0x10001
    s_lshl_b32 s6, s6, 12
    s_or_b32 s7, s7, s6
    s_bfe_u32 s6, s4, 0x10002
    s_lshl_b32 s6, s6, 22
    s_or_b32 s7, s7, s6
    v_mov_b32 v1, 0xff800000
    v_mov_b32 v2, 0
    s_waitcnt lgkmcnt(0)
    s_mov_b32 s40, s18
    s_mov_b32 s41, s19
    s_mov_b32 s42, 0x8000000
    s_mov_b32 s43, 0x20000
    s_mov_b32 s44, s20
    s_mov_b32 s45, s21
    s_mov_b32 s46, 0x8000000
    s_mov_b32 s47, 0x20000
    s_barrier
    s_xor_b32 s6, s7, 0x0
    buffer_load_dwordx4 v[24:27], v0, s[40:43], s6 offen offset:0 nt
    buffer_load_dwordx4 v[28:31], v0, s[40:43], s6 offen offset:256 nt
    buffer_load_dwordx4 v[32:35], v0, s[40:43], s6 offen offset:2048 nt
    buffer_load_dwordx4 v[36:39], v0, s[40:43], s6 offen offset:2304 nt
    s_xor_b32 s6, s7, 0x800000
    buffer_load_dwordx4 v[40:43], v0, s[40:43], s6 offen offset:0 nt
    s_waitcnt vmcnt(4)
    buffer_load_dwordx4 v[44:47], v0, s[40:43], s6 offen offset:256 nt
    s_waitcnt vmcnt(4)
    buffer_load_dwordx4 v[48:51], v0, s[40:43], s6 offen offset:2048 nt
    s_waitcnt vmcnt(4)
    buffer_load_dwordx4 v[52:55], v0, s[40:43], s6 offen offset:2304 nt
    s_xor_b32 s6, s7, 0x10000
    s_waitcnt vmcnt(4)
    buffer_load_dwordx4 v[56:59], v0, s[40:43], s6 offen offset:0 nt
    s_waitcnt vmcnt(4)
    buffer_load_dwordx4 v[60:63], v0, s[40:43], s6 offen offset:256 nt
    s_waitcnt vmcnt(4)
    buffer_load_dwordx4 v[64:67], v0, s[40:43], s6 offen offset:2048 nt
    s_waitcnt vmcnt(4)
    buffer_load_dwordx4 v[68:71], v0, s[40:43], s6 offen offset:2304 nt
    s_xor_b32 s6, s7, 0x810000
    s_waitcnt vmcnt(4)
    buffer_load_dwordx4 v[72:75], v0, s[40:43], s6 offen offset:0 nt
    s_waitcnt vmcnt(4)
    buffer_load_dwordx4 v[76:79], v0, s[40:43], s6 offen offset:256 nt
    s_waitcnt vmcnt(4)
    buffer_load_dwordx4 v[80:83], v0, s[40:43], s6 offen offset:2048 nt
    s_waitcnt vmcnt(4)
    buffer_load_dwordx4 v[84:87], v0, s[40:43], s6 offen offset:2304 nt
    s_xor_b32 s6, s7, 0x1000
    s_waitcnt vmcnt(4)
    buffer_load_dwordx4 v[88:91], v0, s[40:43], s6 offen offset:0 nt
    s_waitcnt vmcnt(4)
    buffer_load_dwordx4 v[92:95], v0, s[40:43], s6 offen offset:256 nt
    s_waitcnt vmcnt(4)
    buffer_load_dwordx4 v[96:99], v0, s[40:43], s6 offen offset:2048 nt
    s_waitcnt vmcnt(4)
    buffer_load_dwordx4 v[100:103], v0, s[40:43], s6 offen offset:2304 nt
    s_xor_b32 s6, s7, 0x801000
    s_waitcnt vmcnt(4)
    buffer_load_dwordx4 v[104:107], v0, s[40:43], s6 offen offset:0 nt
    s_waitcnt vmcnt(4)
    buffer_load_dwordx4 v[108:111], v0, s[40:43], s6 offen offset:256 nt
    s_waitcnt vmcnt(4)
    buffer_load_dwordx4 v[112:115], v0, s[40:43], s6 offen offset:2048 nt
    s_waitcnt vmcnt(4)
    buffer_load_dwordx4 v[116:119], v0, s[40:43], s6 offen offset:2304 nt
    s_xor_b32 s6, s7, 0x11000
    s_waitcnt vmcnt(4)
    buffer_load_dwordx4 v[120:123], v0, s[40:43], s6 offen offset:0 nt
    s_waitcnt vmcnt(4)
    buffer_load_dwordx4 v[124:127], v0, s[40:43], s6 offen offset:256 nt
    s_waitcnt vmcnt(4)
    buffer_load_dwordx4 v[128:131], v0, s[40:43], s6 offen offset:2048 nt
    s_waitcnt vmcnt(4)
    buffer_load_dwordx4 v[132:135], v0, s[40:43], s6 offen offset:2304 nt
    s_xor_b32 s6, s7, 0x811000
    s_waitcnt vmcnt(4)
    buffer_load_dwordx4 v[136:139], v0, s[40:43], s6 offen offset:0 nt
    s_waitcnt vmcnt(4)
    buffer_load_dwordx4 v[140:143], v0, s[40:43], s6 offen offset:256 nt
    s_waitcnt vmcnt(4)
    buffer_load_dwordx4 v[144:147], v0, s[40:43], s6 offen offset:2048 nt
    s_waitcnt vmcnt(4)
    buffer_load_dwordx4 v[148:151], v0, s[40:43], s6 offen offset:2304 nt
    s_xor_b32 s6, s7, 0x400000
    s_waitcnt vmcnt(4)
    buffer_load_dwordx4 v[152:155], v0, s[40:43], s6 offen offset:0 nt
    s_waitcnt vmcnt(4)
    buffer_load_dwordx4 v[156:159], v0, s[40:43], s6 offen offset:256 nt
    s_waitcnt vmcnt(4)
    buffer_load_dwordx4 v[160:163], v0, s[40:43], s6 offen offset:2048 nt
    s_waitcnt vmcnt(4)
    buffer_load_dwordx4 v[164:167], v0, s[40:43], s6 offen offset:2304 nt
    s_xor_b32 s6, s7, 0xc00000
    s_waitcnt vmcnt(4)
    buffer_load_dwordx4 v[168:171], v0, s[40:43], s6 offen offset:0 nt
    s_waitcnt vmcnt(4)
    buffer_load_dwordx4 v[172:175], v0, s[40:43], s6 offen offset:256 nt
    s_waitcnt vmcnt(4)
    buffer_load_dwordx4 v[176:179], v0, s[40:43], s6 offen offset:2048 nt
    s_waitcnt vmcnt(4)
    buffer_load_dwordx4 v[180:183], v0, s[40:43], s6 offen offset:2304 nt
    s_xor_b32 s6, s7, 0x410000
    s_waitcnt vmcnt(4)
    buffer_load_dwordx4 v[184:187], v0, s[40:43], s6 offen offset:0 nt
    s_waitcnt vmcnt(4)
    buffer_load_dwordx4 v[188:191], v0, s[40:43], s6 offen offset:256 nt
    s_waitcnt vmcnt(4)
    buffer_load_dwordx4 v[192:195], v0, s[40:43], s6 offen offset:2048 nt
    s_waitcnt vmcnt(4)
    buffer_load_dwordx4 v[196:199], v0, s[40:43], s6 offen offset:2304 nt
    s_xor_b32 s6, s7, 0xc10000
    s_waitcnt vmcnt(4)
    buffer_load_dwordx4 v[200:203], v0, s[40:43], s6 offen offset:0 nt
    s_waitcnt vmcnt(4)
    buffer_load_dwordx4 v[204:207], v0, s[40:43], s6 offen offset:256 nt
    s_waitcnt vmcnt(4)
    buffer_load_dwordx4 v[208:211], v0, s[40:43], s6 offen offset:2048 nt
    s_waitcnt vmcnt(4)
    buffer_load_dwordx4 v[212:215], v0, s[40:43], s6 offen offset:2304 nt
    s_xor_b32 s6, s7, 0x401000
    s_waitcnt vmcnt(4)
    buffer_load_dwordx4 v[216:219], v0, s[40:43], s6 offen offset:0 nt
    s_waitcnt vmcnt(4)
    buffer_load_dwordx4 v[220:223], v0, s[40:43], s6 offen offset:256 nt
    v_mov_b32 v4, 0
    v_mov_b32 v5, 1
    s_mov_b64 exec, 1
    ds_add_u32 v4, v5 offset:12
    s_mov_b64 exec, -1
    s_waitcnt vmcnt(4)
    buffer_load_dwordx4 v[224:227], v0, s[40:43], s6 offen offset:2048 nt
    s_waitcnt vmcnt(4)
    buffer_load_dwordx4 v[228:231], v0, s[40:43], s6 offen offset:2304 nt
    s_xor_b32 s6, s7, 0xc01000
    s_waitcnt vmcnt(4)
    buffer_load_dwordx4 v[232:235], v0, s[40:43], s6 offen offset:0 nt
    s_waitcnt vmcnt(4)
    buffer_load_dwordx4 v[236:239], v0, s[40:43], s6 offen offset:256 nt
    s_waitcnt vmcnt(4)
    buffer_load_dwordx4 v[240:243], v0, s[40:43], s6 offen offset:2048 nt
    s_waitcnt vmcnt(4)
    buffer_load_dwordx4 v[244:247], v0, s[40:43], s6 offen offset:2304 nt
    s_xor_b32 s6, s7, 0x411000
    s_waitcnt vmcnt(4)
    buffer_load_dwordx4 v[248:251], v0, s[40:43], s6 offen offset:0 nt
    s_waitcnt vmcnt(4)
    buffer_load_dwordx4 v[252:255], v0, s[40:43], s6 offen offset:256 nt
    s_waitcnt lgkmcnt(0)
    v_and_b32 v4, 15, v3
    v_lshlrev_b32 v5, 4, v4
    v_lshrrev_b32 v4, 3, v4
    v_lshlrev_b32 v4, 9, v4
    v_add_u32 v5, v5, v4
    v_xor_b32 v6, 0x200, v5
    s_barrier
    ds_read_b128 v[8:11], v5 offset:256
    ds_read_b128 v[12:15], v5 offset:512
    ds_read_b128 v[16:19], v6 offset:256
    ds_read_b128 v[20:23], v6 offset:512
    s_waitcnt lgkmcnt(0)
    v_dot2_f32_bf16 v4, v24, v8, 0
    v_dot2_f32_bf16 v5, v24, v16, 0
    v_dot2_f32_bf16 v6, v32, v8, 0
    v_dot2_f32_bf16 v7, v32, v16, 0
    v_dot2c_f32_bf16 v4, v25, v9
    v_dot2c_f32_bf16 v5, v25, v17
    v_dot2c_f32_bf16 v6, v33, v9
    v_dot2c_f32_bf16 v7, v33, v17
    v_dot2c_f32_bf16 v4, v26, v10
    v_dot2c_f32_bf16 v5, v26, v18
    v_dot2c_f32_bf16 v6, v34, v10
    v_dot2c_f32_bf16 v7, v34, v18
    v_dot2c_f32_bf16 v4, v27, v11
    v_dot2c_f32_bf16 v5, v27, v19
    v_dot2c_f32_bf16 v6, v35, v11
    v_dot2c_f32_bf16 v7, v35, v19
    v_dot2c_f32_bf16 v4, v28, v12
    v_dot2c_f32_bf16 v5, v28, v20
    v_dot2c_f32_bf16 v6, v36, v12
    v_dot2c_f32_bf16 v7, v36, v20
    v_dot2c_f32_bf16 v4, v29, v13
    v_dot2c_f32_bf16 v5, v29, v21
    v_dot2c_f32_bf16 v6, v37, v13
    v_dot2c_f32_bf16 v7, v37, v21
    v_dot2c_f32_bf16 v4, v30, v14
    v_dot2c_f32_bf16 v5, v30, v22
    v_dot2c_f32_bf16 v6, v38, v14
    v_dot2c_f32_bf16 v7, v38, v22
    v_dot2c_f32_bf16 v4, v31, v15
    v_dot2c_f32_bf16 v5, v31, v23
    v_dot2c_f32_bf16 v6, v39, v15
    v_dot2c_f32_bf16 v7, v39, v23
    s_nop 0
    v_add_f32_dpp v4, v5, v4 row_ror:8 row_mask:0xf bank_mask:0xf
    s_nop 0
    v_add_f32_dpp v6, v7, v6 row_ror:8 row_mask:0xf bank_mask:0xf
    v_add_f32_dpp v4, v4, v4 row_half_mirror row_mask:0xf bank_mask:0xf
    s_nop 0
    v_add_f32_dpp v6, v6, v6 row_half_mirror row_mask:0xf bank_mask:0xf
    v_add_f32_dpp v4, v4, v4 quad_perm:[1,0,3,2] row_mask:0xf bank_mask:0xf
    s_nop 0
    v_add_f32_dpp v6, v6, v6 quad_perm:[1,0,3,2] row_mask:0xf bank_mask:0xf
    v_add_f32_dpp v4, v4, v4 quad_perm:[2,3,0,1] row_mask:0xf bank_mask:0xf
    s_nop 0
    v_add_f32_dpp v6, v6, v6 quad_perm:[2,3,0,1] row_mask:0xf bank_mask:0xf
    v_cvt_pk_bf16_f32 v24, 0, v4
    v_cvt_pk_bf16_f32 v25, 0, v6
    v_max3_f32 v1, v1, v24, v25
    s_waitcnt vmcnt(4)
    buffer_load_dwordx4 v[32:35], v0, s[40:43], s6 offen offset:2048 nt
    s_waitcnt vmcnt(4)
    buffer_load_dwordx4 v[36:39], v0, s[40:43], s6 offen offset:2304 nt
    v_dot2_f32_bf16 v4, v40, v8, 0
    v_dot2_f32_bf16 v5, v40, v16, 0
    v_dot2_f32_bf16 v6, v48, v8, 0
    v_dot2_f32_bf16 v7, v48, v16, 0
    v_dot2c_f32_bf16 v4, v41, v9
    v_dot2c_f32_bf16 v5, v41, v17
    v_dot2c_f32_bf16 v6, v49, v9
    v_dot2c_f32_bf16 v7, v49, v17
    v_dot2c_f32_bf16 v4, v42, v10
    v_dot2c_f32_bf16 v5, v42, v18
    v_dot2c_f32_bf16 v6, v50, v10
    v_dot2c_f32_bf16 v7, v50, v18
    v_dot2c_f32_bf16 v4, v43, v11
    v_dot2c_f32_bf16 v5, v43, v19
    v_dot2c_f32_bf16 v6, v51, v11
    v_dot2c_f32_bf16 v7, v51, v19
    v_dot2c_f32_bf16 v4, v44, v12
    v_dot2c_f32_bf16 v5, v44, v20
    v_dot2c_f32_bf16 v6, v52, v12
    v_dot2c_f32_bf16 v7, v52, v20
    v_dot2c_f32_bf16 v4, v45, v13
    v_dot2c_f32_bf16 v5, v45, v21
    v_dot2c_f32_bf16 v6, v53, v13
    v_dot2c_f32_bf16 v7, v53, v21
    v_dot2c_f32_bf16 v4, v46, v14
    v_dot2c_f32_bf16 v5, v46, v22
    v_dot2c_f32_bf16 v6, v54, v14
    v_dot2c_f32_bf16 v7, v54, v22
    v_dot2c_f32_bf16 v4, v47, v15
    v_dot2c_f32_bf16 v5, v47, v23
    v_dot2c_f32_bf16 v6, v55, v15
    v_dot2c_f32_bf16 v7, v55, v23
    s_nop 0
    v_add_f32_dpp v4, v5, v4 row_ror:8 row_mask:0xf bank_mask:0xf
    s_nop 0
    v_add_f32_dpp v6, v7, v6 row_ror:8 row_mask:0xf bank_mask:0xf
    v_add_f32_dpp v4, v4, v4 row_half_mirror row_mask:0xf bank_mask:0xf
    s_nop 0
    v_add_f32_dpp v6, v6, v6 row_half_mirror row_mask:0xf bank_mask:0xf
    v_add_f32_dpp v4, v4, v4 quad_perm:[1,0,3,2] row_mask:0xf bank_mask:0xf
    s_nop 0
    v_add_f32_dpp v6, v6, v6 quad_perm:[1,0,3,2] row_mask:0xf bank_mask:0xf
    v_add_f32_dpp v4, v4, v4 quad_perm:[2,3,0,1] row_mask:0xf bank_mask:0xf
    s_nop 0
    v_add_f32_dpp v6, v6, v6 quad_perm:[2,3,0,1] row_mask:0xf bank_mask:0xf
    v_cvt_pk_bf16_f32 v26, 0, v4
    v_cvt_pk_bf16_f32 v27, 0, v6
    v_max3_f32 v1, v1, v26, v27
    s_xor_b32 s6, s7, 0xc11000
    s_waitcnt vmcnt(4)
    buffer_load_dwordx4 v[40:43], v0, s[40:43], s6 offen offset:0 nt
    s_waitcnt vmcnt(4)
    buffer_load_dwordx4 v[44:47], v0, s[40:43], s6 offen offset:256 nt
    s_waitcnt vmcnt(4)
    buffer_load_dwordx4 v[48:51], v0, s[40:43], s6 offen offset:2048 nt
    s_waitcnt vmcnt(4)
    buffer_load_dwordx4 v[52:55], v0, s[40:43], s6 offen offset:2304 nt
    v_dot2_f32_bf16 v4, v56, v8, 0
    v_dot2_f32_bf16 v5, v56, v16, 0
    v_dot2_f32_bf16 v6, v64, v8, 0
    v_dot2_f32_bf16 v7, v64, v16, 0
    v_dot2c_f32_bf16 v4, v57, v9
    v_dot2c_f32_bf16 v5, v57, v17
    v_dot2c_f32_bf16 v6, v65, v9
    v_dot2c_f32_bf16 v7, v65, v17
    v_dot2c_f32_bf16 v4, v58, v10
    v_dot2c_f32_bf16 v5, v58, v18
    v_dot2c_f32_bf16 v6, v66, v10
    v_dot2c_f32_bf16 v7, v66, v18
    v_dot2c_f32_bf16 v4, v59, v11
    v_dot2c_f32_bf16 v5, v59, v19
    v_dot2c_f32_bf16 v6, v67, v11
    v_dot2c_f32_bf16 v7, v67, v19
    v_dot2c_f32_bf16 v4, v60, v12
    v_dot2c_f32_bf16 v5, v60, v20
    v_dot2c_f32_bf16 v6, v68, v12
    v_dot2c_f32_bf16 v7, v68, v20
    v_dot2c_f32_bf16 v4, v61, v13
    v_dot2c_f32_bf16 v5, v61, v21
    v_dot2c_f32_bf16 v6, v69, v13
    v_dot2c_f32_bf16 v7, v69, v21
    v_dot2c_f32_bf16 v4, v62, v14
    v_dot2c_f32_bf16 v5, v62, v22
    v_dot2c_f32_bf16 v6, v70, v14
    v_dot2c_f32_bf16 v7, v70, v22
    v_dot2c_f32_bf16 v4, v63, v15
    v_dot2c_f32_bf16 v5, v63, v23
    v_dot2c_f32_bf16 v6, v71, v15
    v_dot2c_f32_bf16 v7, v71, v23
    s_nop 0
    v_add_f32_dpp v4, v5, v4 row_ror:8 row_mask:0xf bank_mask:0xf
    s_nop 0
    v_add_f32_dpp v6, v7, v6 row_ror:8 row_mask:0xf bank_mask:0xf
    v_add_f32_dpp v4, v4, v4 row_half_mirror row_mask:0xf bank_mask:0xf
    s_nop 0
    v_add_f32_dpp v6, v6, v6 row_half_mirror row_mask:0xf bank_mask:0xf
    v_add_f32_dpp v4, v4, v4 quad_perm:[1,0,3,2] row_mask:0xf bank_mask:0xf
    s_nop 0
    v_add_f32_dpp v6, v6, v6 quad_perm:[1,0,3,2] row_mask:0xf bank_mask:0xf
    v_add_f32_dpp v4, v4, v4 quad_perm:[2,3,0,1] row_mask:0xf bank_mask:0xf
    s_nop 0
    v_add_f32_dpp v6, v6, v6 quad_perm:[2,3,0,1] row_mask:0xf bank_mask:0xf
    v_cvt_pk_bf16_f32 v28, 0, v4
    v_cvt_pk_bf16_f32 v29, 0, v6
    v_max3_f32 v1, v1, v28, v29
    s_xor_b32 s6, s7, 0x40000
    s_waitcnt vmcnt(4)
    buffer_load_dwordx4 v[56:59], v0, s[40:43], s6 offen offset:0 nt
    s_waitcnt vmcnt(4)
    buffer_load_dwordx4 v[60:63], v0, s[40:43], s6 offen offset:256 nt
    v_dot2_f32_bf16 v4, v72, v8, 0
    v_dot2_f32_bf16 v5, v72, v16, 0
    v_dot2_f32_bf16 v6, v80, v8, 0
    v_dot2_f32_bf16 v7, v80, v16, 0
    v_dot2c_f32_bf16 v4, v73, v9
    v_dot2c_f32_bf16 v5, v73, v17
    v_dot2c_f32_bf16 v6, v81, v9
    v_dot2c_f32_bf16 v7, v81, v17
    v_dot2c_f32_bf16 v4, v74, v10
    v_dot2c_f32_bf16 v5, v74, v18
    v_dot2c_f32_bf16 v6, v82, v10
    v_dot2c_f32_bf16 v7, v82, v18
    v_dot2c_f32_bf16 v4, v75, v11
    v_dot2c_f32_bf16 v5, v75, v19
    v_dot2c_f32_bf16 v6, v83, v11
    v_dot2c_f32_bf16 v7, v83, v19
    v_dot2c_f32_bf16 v4, v76, v12
    v_dot2c_f32_bf16 v5, v76, v20
    v_dot2c_f32_bf16 v6, v84, v12
    v_dot2c_f32_bf16 v7, v84, v20
    v_dot2c_f32_bf16 v4, v77, v13
    v_dot2c_f32_bf16 v5, v77, v21
    v_dot2c_f32_bf16 v6, v85, v13
    v_dot2c_f32_bf16 v7, v85, v21
    v_dot2c_f32_bf16 v4, v78, v14
    v_dot2c_f32_bf16 v5, v78, v22
    v_dot2c_f32_bf16 v6, v86, v14
    v_dot2c_f32_bf16 v7, v86, v22
    v_dot2c_f32_bf16 v4, v79, v15
    v_dot2c_f32_bf16 v5, v79, v23
    v_dot2c_f32_bf16 v6, v87, v15
    v_dot2c_f32_bf16 v7, v87, v23
    s_nop 0
    v_add_f32_dpp v4, v5, v4 row_ror:8 row_mask:0xf bank_mask:0xf
    s_nop 0
    v_add_f32_dpp v6, v7, v6 row_ror:8 row_mask:0xf bank_mask:0xf
    v_add_f32_dpp v4, v4, v4 row_half_mirror row_mask:0xf bank_mask:0xf
    s_nop 0
    v_add_f32_dpp v6, v6, v6 row_half_mirror row_mask:0xf bank_mask:0xf
    v_add_f32_dpp v4, v4, v4 quad_perm:[1,0,3,2] row_mask:0xf bank_mask:0xf
    s_nop 0
    v_add_f32_dpp v6, v6, v6 quad_perm:[1,0,3,2] row_mask:0xf bank_mask:0xf
    v_add_f32_dpp v4, v4, v4 quad_perm:[2,3,0,1] row_mask:0xf bank_mask:0xf
    s_nop 0
    v_add_f32_dpp v6, v6, v6 quad_perm:[2,3,0,1] row_mask:0xf bank_mask:0xf
    v_cvt_pk_bf16_f32 v30, 0, v4
    v_cvt_pk_bf16_f32 v31, 0, v6
    v_max3_f32 v1, v1, v30, v31
    s_waitcnt vmcnt(4)
    buffer_load_dwordx4 v[64:67], v0, s[40:43], s6 offen offset:2048 nt
    s_waitcnt vmcnt(4)
    buffer_load_dwordx4 v[68:71], v0, s[40:43], s6 offen offset:2304 nt
    v_dot2_f32_bf16 v4, v88, v8, 0
    v_dot2_f32_bf16 v5, v88, v16, 0
    v_dot2_f32_bf16 v6, v96, v8, 0
    v_dot2_f32_bf16 v7, v96, v16, 0
    v_dot2c_f32_bf16 v4, v89, v9
    v_dot2c_f32_bf16 v5, v89, v17
    v_dot2c_f32_bf16 v6, v97, v9
    v_dot2c_f32_bf16 v7, v97, v17
    v_dot2c_f32_bf16 v4, v90, v10
    v_dot2c_f32_bf16 v5, v90, v18
    v_dot2c_f32_bf16 v6, v98, v10
    v_dot2c_f32_bf16 v7, v98, v18
    v_dot2c_f32_bf16 v4, v91, v11
    v_dot2c_f32_bf16 v5, v91, v19
    v_dot2c_f32_bf16 v6, v99, v11
    v_dot2c_f32_bf16 v7, v99, v19
    v_dot2c_f32_bf16 v4, v92, v12
    v_dot2c_f32_bf16 v5, v92, v20
    v_dot2c_f32_bf16 v6, v100, v12
    v_dot2c_f32_bf16 v7, v100, v20
    v_dot2c_f32_bf16 v4, v93, v13
    v_dot2c_f32_bf16 v5, v93, v21
    v_dot2c_f32_bf16 v6, v101, v13
    v_dot2c_f32_bf16 v7, v101, v21
    v_dot2c_f32_bf16 v4, v94, v14
    v_dot2c_f32_bf16 v5, v94, v22
    v_dot2c_f32_bf16 v6, v102, v14
    v_dot2c_f32_bf16 v7, v102, v22
    v_dot2c_f32_bf16 v4, v95, v15
    v_dot2c_f32_bf16 v5, v95, v23
    v_dot2c_f32_bf16 v6, v103, v15
    v_dot2c_f32_bf16 v7, v103, v23
    s_nop 0
    v_add_f32_dpp v4, v5, v4 row_ror:8 row_mask:0xf bank_mask:0xf
    s_nop 0
    v_add_f32_dpp v6, v7, v6 row_ror:8 row_mask:0xf bank_mask:0xf
    v_add_f32_dpp v4, v4, v4 row_half_mirror row_mask:0xf bank_mask:0xf
    s_nop 0
    v_add_f32_dpp v6, v6, v6 row_half_mirror row_mask:0xf bank_mask:0xf
    v_add_f32_dpp v4, v4, v4 quad_perm:[1,0,3,2] row_mask:0xf bank_mask:0xf
    s_nop 0
    v_add_f32_dpp v6, v6, v6 quad_perm:[1,0,3,2] row_mask:0xf bank_mask:0xf
    v_add_f32_dpp v4, v4, v4 quad_perm:[2,3,0,1] row_mask:0xf bank_mask:0xf
    s_nop 0
    v_add_f32_dpp v6, v6, v6 quad_perm:[2,3,0,1] row_mask:0xf bank_mask:0xf
    v_cvt_pk_bf16_f32 v88, 0, v4
    v_cvt_pk_bf16_f32 v89, 0, v6
    v_max3_f32 v1, v1, v88, v89
    s_xor_b32 s6, s7, 0x840000
    s_waitcnt vmcnt(4)
    buffer_load_dwordx4 v[72:75], v0, s[40:43], s6 offen offset:0 nt
    s_waitcnt vmcnt(4)
    buffer_load_dwordx4 v[76:79], v0, s[40:43], s6 offen offset:256 nt
    v_dot2_f32_bf16 v4, v104, v8, 0
    v_dot2_f32_bf16 v5, v104, v16, 0
    v_dot2_f32_bf16 v6, v112, v8, 0
    v_dot2_f32_bf16 v7, v112, v16, 0
    v_dot2c_f32_bf16 v4, v105, v9
    v_dot2c_f32_bf16 v5, v105, v17
    v_dot2c_f32_bf16 v6, v113, v9
    v_dot2c_f32_bf16 v7, v113, v17
    v_dot2c_f32_bf16 v4, v106, v10
    v_dot2c_f32_bf16 v5, v106, v18
    v_dot2c_f32_bf16 v6, v114, v10
    v_dot2c_f32_bf16 v7, v114, v18
    v_dot2c_f32_bf16 v4, v107, v11
    v_dot2c_f32_bf16 v5, v107, v19
    v_dot2c_f32_bf16 v6, v115, v11
    v_dot2c_f32_bf16 v7, v115, v19
    v_dot2c_f32_bf16 v4, v108, v12
    v_dot2c_f32_bf16 v5, v108, v20
    v_dot2c_f32_bf16 v6, v116, v12
    v_dot2c_f32_bf16 v7, v116, v20
    v_dot2c_f32_bf16 v4, v109, v13
    v_dot2c_f32_bf16 v5, v109, v21
    v_dot2c_f32_bf16 v6, v117, v13
    v_dot2c_f32_bf16 v7, v117, v21
    v_dot2c_f32_bf16 v4, v110, v14
    v_dot2c_f32_bf16 v5, v110, v22
    v_dot2c_f32_bf16 v6, v118, v14
    v_dot2c_f32_bf16 v7, v118, v22
    v_dot2c_f32_bf16 v4, v111, v15
    v_dot2c_f32_bf16 v5, v111, v23
    v_dot2c_f32_bf16 v6, v119, v15
    v_dot2c_f32_bf16 v7, v119, v23
    s_nop 0
    v_add_f32_dpp v4, v5, v4 row_ror:8 row_mask:0xf bank_mask:0xf
    s_nop 0
    v_add_f32_dpp v6, v7, v6 row_ror:8 row_mask:0xf bank_mask:0xf
    v_add_f32_dpp v4, v4, v4 row_half_mirror row_mask:0xf bank_mask:0xf
    s_nop 0
    v_add_f32_dpp v6, v6, v6 row_half_mirror row_mask:0xf bank_mask:0xf
    v_add_f32_dpp v4, v4, v4 quad_perm:[1,0,3,2] row_mask:0xf bank_mask:0xf
    s_nop 0
    v_add_f32_dpp v6, v6, v6 quad_perm:[1,0,3,2] row_mask:0xf bank_mask:0xf
    v_add_f32_dpp v4, v4, v4 quad_perm:[2,3,0,1] row_mask:0xf bank_mask:0xf
    s_nop 0
    v_add_f32_dpp v6, v6, v6 quad_perm:[2,3,0,1] row_mask:0xf bank_mask:0xf
    v_cvt_pk_bf16_f32 v90, 0, v4
    v_cvt_pk_bf16_f32 v91, 0, v6
    v_max3_f32 v1, v1, v90, v91
    s_waitcnt vmcnt(4)
    buffer_load_dwordx4 v[80:83], v0, s[40:43], s6 offen offset:2048 nt
    s_waitcnt vmcnt(4)
    buffer_load_dwordx4 v[84:87], v0, s[40:43], s6 offen offset:2304 nt
    v_dot2_f32_bf16 v4, v120, v8, 0
    v_dot2_f32_bf16 v5, v120, v16, 0
    v_dot2_f32_bf16 v6, v128, v8, 0
    v_dot2_f32_bf16 v7, v128, v16, 0
    v_dot2c_f32_bf16 v4, v121, v9
    v_dot2c_f32_bf16 v5, v121, v17
    v_dot2c_f32_bf16 v6, v129, v9
    v_dot2c_f32_bf16 v7, v129, v17
    v_dot2c_f32_bf16 v4, v122, v10
    v_dot2c_f32_bf16 v5, v122, v18
    v_dot2c_f32_bf16 v6, v130, v10
    v_dot2c_f32_bf16 v7, v130, v18
    v_dot2c_f32_bf16 v4, v123, v11
    v_dot2c_f32_bf16 v5, v123, v19
    v_dot2c_f32_bf16 v6, v131, v11
    v_dot2c_f32_bf16 v7, v131, v19
    v_dot2c_f32_bf16 v4, v124, v12
    v_dot2c_f32_bf16 v5, v124, v20
    v_dot2c_f32_bf16 v6, v132, v12
    v_dot2c_f32_bf16 v7, v132, v20
    v_dot2c_f32_bf16 v4, v125, v13
    v_dot2c_f32_bf16 v5, v125, v21
    v_dot2c_f32_bf16 v6, v133, v13
    v_dot2c_f32_bf16 v7, v133, v21
    v_dot2c_f32_bf16 v4, v126, v14
    v_dot2c_f32_bf16 v5, v126, v22
    v_dot2c_f32_bf16 v6, v134, v14
    v_dot2c_f32_bf16 v7, v134, v22
    v_dot2c_f32_bf16 v4, v127, v15
    v_dot2c_f32_bf16 v5, v127, v23
    v_dot2c_f32_bf16 v6, v135, v15
    v_dot2c_f32_bf16 v7, v135, v23
    s_nop 0
    v_add_f32_dpp v4, v5, v4 row_ror:8 row_mask:0xf bank_mask:0xf
    s_nop 0
    v_add_f32_dpp v6, v7, v6 row_ror:8 row_mask:0xf bank_mask:0xf
    v_add_f32_dpp v4, v4, v4 row_half_mirror row_mask:0xf bank_mask:0xf
    s_nop 0
    v_add_f32_dpp v6, v6, v6 row_half_mirror row_mask:0xf bank_mask:0xf
    v_add_f32_dpp v4, v4, v4 quad_perm:[1,0,3,2] row_mask:0xf bank_mask:0xf
    s_nop 0
    v_add_f32_dpp v6, v6, v6 quad_perm:[1,0,3,2] row_mask:0xf bank_mask:0xf
    v_add_f32_dpp v4, v4, v4 quad_perm:[2,3,0,1] row_mask:0xf bank_mask:0xf
    s_nop 0
    v_add_f32_dpp v6, v6, v6 quad_perm:[2,3,0,1] row_mask:0xf bank_mask:0xf
    v_cvt_pk_bf16_f32 v92, 0, v4
    v_cvt_pk_bf16_f32 v93, 0, v6
    v_max3_f32 v1, v1, v92, v93
    s_xor_b32 s6, s7, 0x50000
    s_waitcnt vmcnt(4)
    buffer_load_dwordx4 v[96:99], v0, s[40:43], s6 offen offset:0 nt
    s_waitcnt vmcnt(4)
    buffer_load_dwordx4 v[100:103], v0, s[40:43], s6 offen offset:256 nt
    v_dot2_f32_bf16 v4, v136, v8, 0
    v_dot2_f32_bf16 v5, v136, v16, 0
    v_dot2_f32_bf16 v6, v144, v8, 0
    v_dot2_f32_bf16 v7, v144, v16, 0
    v_dot2c_f32_bf16 v4, v137, v9
    v_dot2c_f32_bf16 v5, v137, v17
    v_dot2c_f32_bf16 v6, v145, v9
    v_dot2c_f32_bf16 v7, v145, v17
    v_dot2c_f32_bf16 v4, v138, v10
    v_dot2c_f32_bf16 v5, v138, v18
    v_dot2c_f32_bf16 v6, v146, v10
    v_dot2c_f32_bf16 v7, v146, v18
    v_dot2c_f32_bf16 v4, v139, v11
    v_dot2c_f32_bf16 v5, v139, v19
    v_dot2c_f32_bf16 v6, v147, v11
    v_dot2c_f32_bf16 v7, v147, v19
    v_dot2c_f32_bf16 v4, v140, v12
    v_dot2c_f32_bf16 v5, v140, v20
    v_dot2c_f32_bf16 v6, v148, v12
    v_dot2c_f32_bf16 v7, v148, v20
    v_dot2c_f32_bf16 v4, v141, v13
    v_dot2c_f32_bf16 v5, v141, v21
    v_dot2c_f32_bf16 v6, v149, v13
    v_dot2c_f32_bf16 v7, v149, v21
    v_dot2c_f32_bf16 v4, v142, v14
    v_dot2c_f32_bf16 v5, v142, v22
    v_dot2c_f32_bf16 v6, v150, v14
    v_dot2c_f32_bf16 v7, v150, v22
    v_dot2c_f32_bf16 v4, v143, v15
    v_dot2c_f32_bf16 v5, v143, v23
    v_dot2c_f32_bf16 v6, v151, v15
    v_dot2c_f32_bf16 v7, v151, v23
    s_nop 0
    v_add_f32_dpp v4, v5, v4 row_ror:8 row_mask:0xf bank_mask:0xf
    s_nop 0
    v_add_f32_dpp v6, v7, v6 row_ror:8 row_mask:0xf bank_mask:0xf
    v_add_f32_dpp v4, v4, v4 row_half_mirror row_mask:0xf bank_mask:0xf
    s_nop 0
    v_add_f32_dpp v6, v6, v6 row_half_mirror row_mask:0xf bank_mask:0xf
    v_add_f32_dpp v4, v4, v4 quad_perm:[1,0,3,2] row_mask:0xf bank_mask:0xf
    s_nop 0
    v_add_f32_dpp v6, v6, v6 quad_perm:[1,0,3,2] row_mask:0xf bank_mask:0xf
    v_add_f32_dpp v4, v4, v4 quad_perm:[2,3,0,1] row_mask:0xf bank_mask:0xf
    s_nop 0
    v_add_f32_dpp v6, v6, v6 quad_perm:[2,3,0,1] row_mask:0xf bank_mask:0xf
    v_cvt_pk_bf16_f32 v94, 0, v4
    v_cvt_pk_bf16_f32 v95, 0, v6
    v_max3_f32 v1, v1, v94, v95
    s_waitcnt vmcnt(4)
    buffer_load_dwordx4 v[104:107], v0, s[40:43], s6 offen offset:2048 nt
    s_waitcnt vmcnt(4)
    buffer_load_dwordx4 v[108:111], v0, s[40:43], s6 offen offset:2304 nt
    v_dot2_f32_bf16 v4, v152, v8, 0
    v_dot2_f32_bf16 v5, v152, v16, 0
    v_dot2_f32_bf16 v6, v160, v8, 0
    v_dot2_f32_bf16 v7, v160, v16, 0
    v_dot2c_f32_bf16 v4, v153, v9
    v_dot2c_f32_bf16 v5, v153, v17
    v_dot2c_f32_bf16 v6, v161, v9
    v_dot2c_f32_bf16 v7, v161, v17
    v_dot2c_f32_bf16 v4, v154, v10
    v_dot2c_f32_bf16 v5, v154, v18
    v_dot2c_f32_bf16 v6, v162, v10
    v_dot2c_f32_bf16 v7, v162, v18
    v_dot2c_f32_bf16 v4, v155, v11
    v_dot2c_f32_bf16 v5, v155, v19
    v_dot2c_f32_bf16 v6, v163, v11
    v_dot2c_f32_bf16 v7, v163, v19
    v_dot2c_f32_bf16 v4, v156, v12
    v_dot2c_f32_bf16 v5, v156, v20
    v_dot2c_f32_bf16 v6, v164, v12
    v_dot2c_f32_bf16 v7, v164, v20
    v_dot2c_f32_bf16 v4, v157, v13
    v_dot2c_f32_bf16 v5, v157, v21
    v_dot2c_f32_bf16 v6, v165, v13
    v_dot2c_f32_bf16 v7, v165, v21
    v_dot2c_f32_bf16 v4, v158, v14
    v_dot2c_f32_bf16 v5, v158, v22
    v_dot2c_f32_bf16 v6, v166, v14
    v_dot2c_f32_bf16 v7, v166, v22
    v_dot2c_f32_bf16 v4, v159, v15
    v_dot2c_f32_bf16 v5, v159, v23
    v_dot2c_f32_bf16 v6, v167, v15
    v_dot2c_f32_bf16 v7, v167, v23
    s_nop 0
    v_add_f32_dpp v4, v5, v4 row_ror:8 row_mask:0xf bank_mask:0xf
    s_nop 0
    v_add_f32_dpp v6, v7, v6 row_ror:8 row_mask:0xf bank_mask:0xf
    v_add_f32_dpp v4, v4, v4 row_half_mirror row_mask:0xf bank_mask:0xf
    s_nop 0
    v_add_f32_dpp v6, v6, v6 row_half_mirror row_mask:0xf bank_mask:0xf
    v_add_f32_dpp v4, v4, v4 quad_perm:[1,0,3,2] row_mask:0xf bank_mask:0xf
    s_nop 0
    v_add_f32_dpp v6, v6, v6 quad_perm:[1,0,3,2] row_mask:0xf bank_mask:0xf
    v_add_f32_dpp v4, v4, v4 quad_perm:[2,3,0,1] row_mask:0xf bank_mask:0xf
    s_nop 0
    v_add_f32_dpp v6, v6, v6 quad_perm:[2,3,0,1] row_mask:0xf bank_mask:0xf
    v_cvt_pk_bf16_f32 v152, 0, v4
    v_cvt_pk_bf16_f32 v153, 0, v6
    v_max3_f32 v1, v1, v152, v153
    s_xor_b32 s6, s7, 0x850000
    s_waitcnt vmcnt(4)
    buffer_load_dwordx4 v[112:115], v0, s[40:43], s6 offen offset:0 nt
    s_waitcnt vmcnt(4)
    buffer_load_dwordx4 v[116:119], v0, s[40:43], s6 offen offset:256 nt
    v_dot2_f32_bf16 v4, v168, v8, 0
    v_dot2_f32_bf16 v5, v168, v16, 0
    v_dot2_f32_bf16 v6, v176, v8, 0
    v_dot2_f32_bf16 v7, v176, v16, 0
    v_dot2c_f32_bf16 v4, v169, v9
    v_dot2c_f32_bf16 v5, v169, v17
    v_dot2c_f32_bf16 v6, v177, v9
    v_dot2c_f32_bf16 v7, v177, v17
    v_dot2c_f32_bf16 v4, v170, v10
    v_dot2c_f32_bf16 v5, v170, v18
    v_dot2c_f32_bf16 v6, v178, v10
    v_dot2c_f32_bf16 v7, v178, v18
    v_dot2c_f32_bf16 v4, v171, v11
    v_dot2c_f32_bf16 v5, v171, v19
    v_dot2c_f32_bf16 v6, v179, v11
    v_dot2c_f32_bf16 v7, v179, v19
    v_dot2c_f32_bf16 v4, v172, v12
    v_dot2c_f32_bf16 v5, v172, v20
    v_dot2c_f32_bf16 v6, v180, v12
    v_dot2c_f32_bf16 v7, v180, v20
    v_dot2c_f32_bf16 v4, v173, v13
    v_dot2c_f32_bf16 v5, v173, v21
    v_dot2c_f32_bf16 v6, v181, v13
    v_dot2c_f32_bf16 v7, v181, v21
    v_dot2c_f32_bf16 v4, v174, v14
    v_dot2c_f32_bf16 v5, v174, v22
    v_dot2c_f32_bf16 v6, v182, v14
    v_dot2c_f32_bf16 v7, v182, v22
    v_dot2c_f32_bf16 v4, v175, v15
    v_dot2c_f32_bf16 v5, v175, v23
    v_dot2c_f32_bf16 v6, v183, v15
    v_dot2c_f32_bf16 v7, v183, v23
    s_nop 0
    v_add_f32_dpp v4, v5, v4 row_ror:8 row_mask:0xf bank_mask:0xf
    s_nop 0
    v_add_f32_dpp v6, v7, v6 row_ror:8 row_mask:0xf bank_mask:0xf
    v_add_f32_dpp v4, v4, v4 row_half_mirror row_mask:0xf bank_mask:0xf
    s_nop 0
    v_add_f32_dpp v6, v6, v6 row_half_mirror row_mask:0xf bank_mask:0xf
    v_add_f32_dpp v4, v4, v4 quad_perm:[1,0,3,2] row_mask:0xf bank_mask:0xf
    s_nop 0
    v_add_f32_dpp v6, v6, v6 quad_perm:[1,0,3,2] row_mask:0xf bank_mask:0xf
    v_add_f32_dpp v4, v4, v4 quad_perm:[2,3,0,1] row_mask:0xf bank_mask:0xf
    s_nop 0
    v_add_f32_dpp v6, v6, v6 quad_perm:[2,3,0,1] row_mask:0xf bank_mask:0xf
    v_cvt_pk_bf16_f32 v154, 0, v4
    v_cvt_pk_bf16_f32 v155, 0, v6
    v_max3_f32 v1, v1, v154, v155
    s_waitcnt vmcnt(4)
    buffer_load_dwordx4 v[120:123], v0, s[40:43], s6 offen offset:2048 nt
    s_waitcnt vmcnt(4)
    buffer_load_dwordx4 v[124:127], v0, s[40:43], s6 offen offset:2304 nt
    v_dot2_f32_bf16 v4, v184, v8, 0
    v_dot2_f32_bf16 v5, v184, v16, 0
    v_dot2_f32_bf16 v6, v192, v8, 0
    v_dot2_f32_bf16 v7, v192, v16, 0
    v_dot2c_f32_bf16 v4, v185, v9
    v_dot2c_f32_bf16 v5, v185, v17
    v_dot2c_f32_bf16 v6, v193, v9
    v_dot2c_f32_bf16 v7, v193, v17
    v_dot2c_f32_bf16 v4, v186, v10
    v_dot2c_f32_bf16 v5, v186, v18
    v_dot2c_f32_bf16 v6, v194, v10
    v_dot2c_f32_bf16 v7, v194, v18
    v_dot2c_f32_bf16 v4, v187, v11
    v_dot2c_f32_bf16 v5, v187, v19
    v_dot2c_f32_bf16 v6, v195, v11
    v_dot2c_f32_bf16 v7, v195, v19
    v_dot2c_f32_bf16 v4, v188, v12
    v_dot2c_f32_bf16 v5, v188, v20
    v_dot2c_f32_bf16 v6, v196, v12
    v_dot2c_f32_bf16 v7, v196, v20
    v_dot2c_f32_bf16 v4, v189, v13
    v_dot2c_f32_bf16 v5, v189, v21
    v_dot2c_f32_bf16 v6, v197, v13
    v_dot2c_f32_bf16 v7, v197, v21
    v_dot2c_f32_bf16 v4, v190, v14
    v_dot2c_f32_bf16 v5, v190, v22
    v_dot2c_f32_bf16 v6, v198, v14
    v_dot2c_f32_bf16 v7, v198, v22
    v_dot2c_f32_bf16 v4, v191, v15
    v_dot2c_f32_bf16 v5, v191, v23
    v_dot2c_f32_bf16 v6, v199, v15
    v_dot2c_f32_bf16 v7, v199, v23
    s_nop 0
    v_add_f32_dpp v4, v5, v4 row_ror:8 row_mask:0xf bank_mask:0xf
    s_nop 0
    v_add_f32_dpp v6, v7, v6 row_ror:8 row_mask:0xf bank_mask:0xf
    v_add_f32_dpp v4, v4, v4 row_half_mirror row_mask:0xf bank_mask:0xf
    s_nop 0
    v_add_f32_dpp v6, v6, v6 row_half_mirror row_mask:0xf bank_mask:0xf
    v_add_f32_dpp v4, v4, v4 quad_perm:[1,0,3,2] row_mask:0xf bank_mask:0xf
    s_nop 0
    v_add_f32_dpp v6, v6, v6 quad_perm:[1,0,3,2] row_mask:0xf bank_mask:0xf
    v_add_f32_dpp v4, v4, v4 quad_perm:[2,3,0,1] row_mask:0xf bank_mask:0xf
    s_nop 0
    v_add_f32_dpp v6, v6, v6 quad_perm:[2,3,0,1] row_mask:0xf bank_mask:0xf
    v_cvt_pk_bf16_f32 v156, 0, v4
    v_cvt_pk_bf16_f32 v157, 0, v6
    v_max3_f32 v1, v1, v156, v157
    s_xor_b32 s6, s7, 0x41000
    s_waitcnt vmcnt(4)
    buffer_load_dwordx4 v[128:131], v0, s[40:43], s6 offen offset:0 nt
    s_waitcnt vmcnt(4)
    buffer_load_dwordx4 v[132:135], v0, s[40:43], s6 offen offset:256 nt
    v_dot2_f32_bf16 v4, v200, v8, 0
    v_dot2_f32_bf16 v5, v200, v16, 0
    v_dot2_f32_bf16 v6, v208, v8, 0
    v_dot2_f32_bf16 v7, v208, v16, 0
    v_dot2c_f32_bf16 v4, v201, v9
    v_dot2c_f32_bf16 v5, v201, v17
    v_dot2c_f32_bf16 v6, v209, v9
    v_dot2c_f32_bf16 v7, v209, v17
    v_dot2c_f32_bf16 v4, v202, v10
    v_dot2c_f32_bf16 v5, v202, v18
    v_dot2c_f32_bf16 v6, v210, v10
    v_dot2c_f32_bf16 v7, v210, v18
    v_dot2c_f32_bf16 v4, v203, v11
    v_dot2c_f32_bf16 v5, v203, v19
    v_dot2c_f32_bf16 v6, v211, v11
    v_dot2c_f32_bf16 v7, v211, v19
    v_dot2c_f32_bf16 v4, v204, v12
    v_dot2c_f32_bf16 v5, v204, v20
    v_dot2c_f32_bf16 v6, v212, v12
    v_dot2c_f32_bf16 v7, v212, v20
    v_dot2c_f32_bf16 v4, v205, v13
    v_dot2c_f32_bf16 v5, v205, v21
    v_dot2c_f32_bf16 v6, v213, v13
    v_dot2c_f32_bf16 v7, v213, v21
    v_dot2c_f32_bf16 v4, v206, v14
    v_dot2c_f32_bf16 v5, v206, v22
    v_dot2c_f32_bf16 v6, v214, v14
    v_dot2c_f32_bf16 v7, v214, v22
    v_dot2c_f32_bf16 v4, v207, v15
    v_dot2c_f32_bf16 v5, v207, v23
    v_dot2c_f32_bf16 v6, v215, v15
    v_dot2c_f32_bf16 v7, v215, v23
    s_nop 0
    v_add_f32_dpp v4, v5, v4 row_ror:8 row_mask:0xf bank_mask:0xf
    s_nop 0
    v_add_f32_dpp v6, v7, v6 row_ror:8 row_mask:0xf bank_mask:0xf
    v_add_f32_dpp v4, v4, v4 row_half_mirror row_mask:0xf bank_mask:0xf
    s_nop 0
    v_add_f32_dpp v6, v6, v6 row_half_mirror row_mask:0xf bank_mask:0xf
    v_add_f32_dpp v4, v4, v4 quad_perm:[1,0,3,2] row_mask:0xf bank_mask:0xf
    s_nop 0
    v_add_f32_dpp v6, v6, v6 quad_perm:[1,0,3,2] row_mask:0xf bank_mask:0xf
    v_add_f32_dpp v4, v4, v4 quad_perm:[2,3,0,1] row_mask:0xf bank_mask:0xf
    s_nop 0
    v_add_f32_dpp v6, v6, v6 quad_perm:[2,3,0,1] row_mask:0xf bank_mask:0xf
    v_cvt_pk_bf16_f32 v158, 0, v4
    v_cvt_pk_bf16_f32 v159, 0, v6
    v_max3_f32 v1, v1, v158, v159
    s_waitcnt vmcnt(4)
    buffer_load_dwordx4 v[136:139], v0, s[40:43], s6 offen offset:2048 nt
    s_waitcnt vmcnt(4)
    buffer_load_dwordx4 v[140:143], v0, s[40:43], s6 offen offset:2304 nt
    v_dot2_f32_bf16 v4, v216, v8, 0
    v_dot2_f32_bf16 v5, v216, v16, 0
    v_dot2_f32_bf16 v6, v224, v8, 0
    v_dot2_f32_bf16 v7, v224, v16, 0
    v_dot2c_f32_bf16 v4, v217, v9
    v_dot2c_f32_bf16 v5, v217, v17
    v_dot2c_f32_bf16 v6, v225, v9
    v_dot2c_f32_bf16 v7, v225, v17
    v_dot2c_f32_bf16 v4, v218, v10
    v_dot2c_f32_bf16 v5, v218, v18
    v_dot2c_f32_bf16 v6, v226, v10
    v_dot2c_f32_bf16 v7, v226, v18
    v_dot2c_f32_bf16 v4, v219, v11
    v_dot2c_f32_bf16 v5, v219, v19
    v_dot2c_f32_bf16 v6, v227, v11
    v_dot2c_f32_bf16 v7, v227, v19
    v_dot2c_f32_bf16 v4, v220, v12
    v_dot2c_f32_bf16 v5, v220, v20
    v_dot2c_f32_bf16 v6, v228, v12
    v_dot2c_f32_bf16 v7, v228, v20
    v_dot2c_f32_bf16 v4, v221, v13
    v_dot2c_f32_bf16 v5, v221, v21
    v_dot2c_f32_bf16 v6, v229, v13
    v_dot2c_f32_bf16 v7, v229, v21
    v_dot2c_f32_bf16 v4, v222, v14
    v_dot2c_f32_bf16 v5, v222, v22
    v_dot2c_f32_bf16 v6, v230, v14
    v_dot2c_f32_bf16 v7, v230, v22
    v_dot2c_f32_bf16 v4, v223, v15
    v_dot2c_f32_bf16 v5, v223, v23
    v_dot2c_f32_bf16 v6, v231, v15
    v_dot2c_f32_bf16 v7, v231, v23
    s_nop 0
    v_add_f32_dpp v4, v5, v4 row_ror:8 row_mask:0xf bank_mask:0xf
    s_nop 0
    v_add_f32_dpp v6, v7, v6 row_ror:8 row_mask:0xf bank_mask:0xf
    v_add_f32_dpp v4, v4, v4 row_half_mirror row_mask:0xf bank_mask:0xf
    s_nop 0
    v_add_f32_dpp v6, v6, v6 row_half_mirror row_mask:0xf bank_mask:0xf
    v_add_f32_dpp v4, v4, v4 quad_perm:[1,0,3,2] row_mask:0xf bank_mask:0xf
    s_nop 0
    v_add_f32_dpp v6, v6, v6 quad_perm:[1,0,3,2] row_mask:0xf bank_mask:0xf
    v_add_f32_dpp v4, v4, v4 quad_perm:[2,3,0,1] row_mask:0xf bank_mask:0xf
    s_nop 0
    v_add_f32_dpp v6, v6, v6 quad_perm:[2,3,0,1] row_mask:0xf bank_mask:0xf
    v_cvt_pk_bf16_f32 v216, 0, v4
    v_cvt_pk_bf16_f32 v217, 0, v6
    v_max3_f32 v1, v1, v216, v217
    s_xor_b32 s6, s7, 0x841000
    s_waitcnt vmcnt(4)
    buffer_load_dwordx4 v[144:147], v0, s[40:43], s6 offen offset:0 nt
    s_waitcnt vmcnt(4)
    buffer_load_dwordx4 v[148:151], v0, s[40:43], s6 offen offset:256 nt
    v_dot2_f32_bf16 v4, v232, v8, 0
    v_dot2_f32_bf16 v5, v232, v16, 0
    v_dot2_f32_bf16 v6, v240, v8, 0
    v_dot2_f32_bf16 v7, v240, v16, 0
    v_dot2c_f32_bf16 v4, v233, v9
    v_dot2c_f32_bf16 v5, v233, v17
    v_dot2c_f32_bf16 v6, v241, v9
    v_dot2c_f32_bf16 v7, v241, v17
    v_dot2c_f32_bf16 v4, v234, v10
    v_dot2c_f32_bf16 v5, v234, v18
    v_dot2c_f32_bf16 v6, v242, v10
    v_dot2c_f32_bf16 v7, v242, v18
    v_dot2c_f32_bf16 v4, v235, v11
    v_dot2c_f32_bf16 v5, v235, v19
    v_dot2c_f32_bf16 v6, v243, v11
    v_dot2c_f32_bf16 v7, v243, v19
    v_dot2c_f32_bf16 v4, v236, v12
    v_dot2c_f32_bf16 v5, v236, v20
    v_dot2c_f32_bf16 v6, v244, v12
    v_dot2c_f32_bf16 v7, v244, v20
    v_dot2c_f32_bf16 v4, v237, v13
    v_dot2c_f32_bf16 v5, v237, v21
    v_dot2c_f32_bf16 v6, v245, v13
    v_dot2c_f32_bf16 v7, v245, v21
    v_dot2c_f32_bf16 v4, v238, v14
    v_dot2c_f32_bf16 v5, v238, v22
    v_dot2c_f32_bf16 v6, v246, v14
    v_dot2c_f32_bf16 v7, v246, v22
    v_dot2c_f32_bf16 v4, v239, v15
    v_dot2c_f32_bf16 v5, v239, v23
    v_dot2c_f32_bf16 v6, v247, v15
    v_dot2c_f32_bf16 v7, v247, v23
    s_nop 0
    v_add_f32_dpp v4, v5, v4 row_ror:8 row_mask:0xf bank_mask:0xf
    s_nop 0
    v_add_f32_dpp v6, v7, v6 row_ror:8 row_mask:0xf bank_mask:0xf
    v_add_f32_dpp v4, v4, v4 row_half_mirror row_mask:0xf bank_mask:0xf
    s_nop 0
    v_add_f32_dpp v6, v6, v6 row_half_mirror row_mask:0xf bank_mask:0xf
    v_add_f32_dpp v4, v4, v4 quad_perm:[1,0,3,2] row_mask:0xf bank_mask:0xf
    s_nop 0
    v_add_f32_dpp v6, v6, v6 quad_perm:[1,0,3,2] row_mask:0xf bank_mask:0xf
    v_add_f32_dpp v4, v4, v4 quad_perm:[2,3,0,1] row_mask:0xf bank_mask:0xf
    s_nop 0
    v_add_f32_dpp v6, v6, v6 quad_perm:[2,3,0,1] row_mask:0xf bank_mask:0xf
    v_cvt_pk_bf16_f32 v218, 0, v4
    v_cvt_pk_bf16_f32 v219, 0, v6
    v_max3_f32 v1, v1, v218, v219
    s_waitcnt vmcnt(4)
    buffer_load_dwordx4 v[160:163], v0, s[40:43], s6 offen offset:2048 nt
    s_waitcnt vmcnt(4)
    buffer_load_dwordx4 v[164:167], v0, s[40:43], s6 offen offset:2304 nt
    v_dot2_f32_bf16 v4, v248, v8, 0
    v_dot2_f32_bf16 v5, v248, v16, 0
    v_dot2_f32_bf16 v6, v32, v8, 0
    v_dot2_f32_bf16 v7, v32, v16, 0
    v_dot2c_f32_bf16 v4, v249, v9
    v_dot2c_f32_bf16 v5, v249, v17
    v_dot2c_f32_bf16 v6, v33, v9
    v_dot2c_f32_bf16 v7, v33, v17
    v_dot2c_f32_bf16 v4, v250, v10
    v_dot2c_f32_bf16 v5, v250, v18
    v_dot2c_f32_bf16 v6, v34, v10
    v_dot2c_f32_bf16 v7, v34, v18
    v_dot2c_f32_bf16 v4, v251, v11
    v_dot2c_f32_bf16 v5, v251, v19
    v_dot2c_f32_bf16 v6, v35, v11
    v_dot2c_f32_bf16 v7, v35, v19
    v_dot2c_f32_bf16 v4, v252, v12
    v_dot2c_f32_bf16 v5, v252, v20
    v_dot2c_f32_bf16 v6, v36, v12
    v_dot2c_f32_bf16 v7, v36, v20
    v_dot2c_f32_bf16 v4, v253, v13
    v_dot2c_f32_bf16 v5, v253, v21
    v_dot2c_f32_bf16 v6, v37, v13
    v_dot2c_f32_bf16 v7, v37, v21
    v_dot2c_f32_bf16 v4, v254, v14
    v_dot2c_f32_bf16 v5, v254, v22
    v_dot2c_f32_bf16 v6, v38, v14
    v_dot2c_f32_bf16 v7, v38, v22
    v_dot2c_f32_bf16 v4, v255, v15
    v_dot2c_f32_bf16 v5, v255, v23
    v_dot2c_f32_bf16 v6, v39, v15
    v_dot2c_f32_bf16 v7, v39, v23
    s_nop 0
    v_add_f32_dpp v4, v5, v4 row_ror:8 row_mask:0xf bank_mask:0xf
    s_nop 0
    v_add_f32_dpp v6, v7, v6 row_ror:8 row_mask:0xf bank_mask:0xf
    v_add_f32_dpp v4, v4, v4 row_half_mirror row_mask:0xf bank_mask:0xf
    s_nop 0
    v_add_f32_dpp v6, v6, v6 row_half_mirror row_mask:0xf bank_mask:0xf
    v_add_f32_dpp v4, v4, v4 quad_perm:[1,0,3,2] row_mask:0xf bank_mask:0xf
    s_nop 0
    v_add_f32_dpp v6, v6, v6 quad_perm:[1,0,3,2] row_mask:0xf bank_mask:0xf
    v_add_f32_dpp v4, v4, v4 quad_perm:[2,3,0,1] row_mask:0xf bank_mask:0xf
    s_nop 0
    v_add_f32_dpp v6, v6, v6 quad_perm:[2,3,0,1] row_mask:0xf bank_mask:0xf
    v_cvt_pk_bf16_f32 v220, 0, v4
    v_cvt_pk_bf16_f32 v221, 0, v6
    v_max3_f32 v1, v1, v220, v221
    s_xor_b32 s6, s7, 0x51000
    s_waitcnt vmcnt(4)
    buffer_load_dwordx4 v[168:171], v0, s[40:43], s6 offen offset:0 nt
    s_waitcnt vmcnt(4)
    buffer_load_dwordx4 v[172:175], v0, s[40:43], s6 offen offset:256 nt
    v_dot2_f32_bf16 v4, v40, v8, 0
    v_dot2_f32_bf16 v5, v40, v16, 0
    v_dot2_f32_bf16 v6, v48, v8, 0
    v_dot2_f32_bf16 v7, v48, v16, 0
    v_dot2c_f32_bf16 v4, v41, v9
    v_dot2c_f32_bf16 v5, v41, v17
    v_dot2c_f32_bf16 v6, v49, v9
    v_dot2c_f32_bf16 v7, v49, v17
    v_dot2c_f32_bf16 v4, v42, v10
    v_dot2c_f32_bf16 v5, v42, v18
    v_dot2c_f32_bf16 v6, v50, v10
    v_dot2c_f32_bf16 v7, v50, v18
    v_dot2c_f32_bf16 v4, v43, v11
    v_dot2c_f32_bf16 v5, v43, v19
    v_dot2c_f32_bf16 v6, v51, v11
    v_dot2c_f32_bf16 v7, v51, v19
    v_dot2c_f32_bf16 v4, v44, v12
    v_dot2c_f32_bf16 v5, v44, v20
    v_dot2c_f32_bf16 v6, v52, v12
    v_dot2c_f32_bf16 v7, v52, v20
    v_dot2c_f32_bf16 v4, v45, v13
    v_dot2c_f32_bf16 v5, v45, v21
    v_dot2c_f32_bf16 v6, v53, v13
    v_dot2c_f32_bf16 v7, v53, v21
    v_dot2c_f32_bf16 v4, v46, v14
    v_dot2c_f32_bf16 v5, v46, v22
    v_dot2c_f32_bf16 v6, v54, v14
    v_dot2c_f32_bf16 v7, v54, v22
    v_dot2c_f32_bf16 v4, v47, v15
    v_dot2c_f32_bf16 v5, v47, v23
    v_dot2c_f32_bf16 v6, v55, v15
    v_dot2c_f32_bf16 v7, v55, v23
    s_nop 0
    v_add_f32_dpp v4, v5, v4 row_ror:8 row_mask:0xf bank_mask:0xf
    s_nop 0
    v_add_f32_dpp v6, v7, v6 row_ror:8 row_mask:0xf bank_mask:0xf
    v_add_f32_dpp v4, v4, v4 row_half_mirror row_mask:0xf bank_mask:0xf
    s_nop 0
    v_add_f32_dpp v6, v6, v6 row_half_mirror row_mask:0xf bank_mask:0xf
    v_add_f32_dpp v4, v4, v4 quad_perm:[1,0,3,2] row_mask:0xf bank_mask:0xf
    s_nop 0
    v_add_f32_dpp v6, v6, v6 quad_perm:[1,0,3,2] row_mask:0xf bank_mask:0xf
    v_add_f32_dpp v4, v4, v4 quad_perm:[2,3,0,1] row_mask:0xf bank_mask:0xf
    s_nop 0
    v_add_f32_dpp v6, v6, v6 quad_perm:[2,3,0,1] row_mask:0xf bank_mask:0xf
    v_cvt_pk_bf16_f32 v222, 0, v4
    v_cvt_pk_bf16_f32 v223, 0, v6
    v_max3_f32 v1, v1, v222, v223
    s_waitcnt vmcnt(4)
    buffer_load_dwordx4 v[176:179], v0, s[40:43], s6 offen offset:2048 nt
    s_waitcnt vmcnt(4)
    buffer_load_dwordx4 v[180:183], v0, s[40:43], s6 offen offset:2304 nt
    v_dot2_f32_bf16 v4, v56, v8, 0
    v_dot2_f32_bf16 v5, v56, v16, 0
    v_dot2_f32_bf16 v6, v64, v8, 0
    v_dot2_f32_bf16 v7, v64, v16, 0
    v_dot2c_f32_bf16 v4, v57, v9
    v_dot2c_f32_bf16 v5, v57, v17
    v_dot2c_f32_bf16 v6, v65, v9
    v_dot2c_f32_bf16 v7, v65, v17
    v_dot2c_f32_bf16 v4, v58, v10
    v_dot2c_f32_bf16 v5, v58, v18
    v_dot2c_f32_bf16 v6, v66, v10
    v_dot2c_f32_bf16 v7, v66, v18
    v_dot2c_f32_bf16 v4, v59, v11
    v_dot2c_f32_bf16 v5, v59, v19
    v_dot2c_f32_bf16 v6, v67, v11
    v_dot2c_f32_bf16 v7, v67, v19
    v_dot2c_f32_bf16 v4, v60, v12
    v_dot2c_f32_bf16 v5, v60, v20
    v_dot2c_f32_bf16 v6, v68, v12
    v_dot2c_f32_bf16 v7, v68, v20
    v_dot2c_f32_bf16 v4, v61, v13
    v_dot2c_f32_bf16 v5, v61, v21
    v_dot2c_f32_bf16 v6, v69, v13
    v_dot2c_f32_bf16 v7, v69, v21
    v_dot2c_f32_bf16 v4, v62, v14
    v_dot2c_f32_bf16 v5, v62, v22
    v_dot2c_f32_bf16 v6, v70, v14
    v_dot2c_f32_bf16 v7, v70, v22
    v_dot2c_f32_bf16 v4, v63, v15
    v_dot2c_f32_bf16 v5, v63, v23
    v_dot2c_f32_bf16 v6, v71, v15
    v_dot2c_f32_bf16 v7, v71, v23
    s_nop 0
    v_add_f32_dpp v4, v5, v4 row_ror:8 row_mask:0xf bank_mask:0xf
    s_nop 0
    v_add_f32_dpp v6, v7, v6 row_ror:8 row_mask:0xf bank_mask:0xf
    v_add_f32_dpp v4, v4, v4 row_half_mirror row_mask:0xf bank_mask:0xf
    s_nop 0
    v_add_f32_dpp v6, v6, v6 row_half_mirror row_mask:0xf bank_mask:0xf
    v_add_f32_dpp v4, v4, v4 quad_perm:[1,0,3,2] row_mask:0xf bank_mask:0xf
    s_nop 0
    v_add_f32_dpp v6, v6, v6 quad_perm:[1,0,3,2] row_mask:0xf bank_mask:0xf
    v_add_f32_dpp v4, v4, v4 quad_perm:[2,3,0,1] row_mask:0xf bank_mask:0xf
    s_nop 0
    v_add_f32_dpp v6, v6, v6 quad_perm:[2,3,0,1] row_mask:0xf bank_mask:0xf
    v_cvt_pk_bf16_f32 v56, 0, v4
    v_cvt_pk_bf16_f32 v57, 0, v6
    v_max3_f32 v1, v1, v56, v57
    s_xor_b32 s6, s7, 0x851000
    s_waitcnt vmcnt(4)
    buffer_load_dwordx4 v[184:187], v0, s[40:43], s6 offen offset:0 nt
    s_waitcnt vmcnt(4)
    buffer_load_dwordx4 v[188:191], v0, s[40:43], s6 offen offset:256 nt
    v_dot2_f32_bf16 v4, v72, v8, 0
    v_dot2_f32_bf16 v5, v72, v16, 0
    v_dot2_f32_bf16 v6, v80, v8, 0
    v_dot2_f32_bf16 v7, v80, v16, 0
    v_dot2c_f32_bf16 v4, v73, v9
    v_dot2c_f32_bf16 v5, v73, v17
    v_dot2c_f32_bf16 v6, v81, v9
    v_dot2c_f32_bf16 v7, v81, v17
    v_dot2c_f32_bf16 v4, v74, v10
    v_dot2c_f32_bf16 v5, v74, v18
    v_dot2c_f32_bf16 v6, v82, v10
    v_dot2c_f32_bf16 v7, v82, v18
    v_dot2c_f32_bf16 v4, v75, v11
    v_dot2c_f32_bf16 v5, v75, v19
    v_dot2c_f32_bf16 v6, v83, v11
    v_dot2c_f32_bf16 v7, v83, v19
    v_dot2c_f32_bf16 v4, v76, v12
    v_dot2c_f32_bf16 v5, v76, v20
    v_dot2c_f32_bf16 v6, v84, v12
    v_dot2c_f32_bf16 v7, v84, v20
    v_dot2c_f32_bf16 v4, v77, v13
    v_dot2c_f32_bf16 v5, v77, v21
    v_dot2c_f32_bf16 v6, v85, v13
    v_dot2c_f32_bf16 v7, v85, v21
    v_dot2c_f32_bf16 v4, v78, v14
    v_dot2c_f32_bf16 v5, v78, v22
    v_dot2c_f32_bf16 v6, v86, v14
    v_dot2c_f32_bf16 v7, v86, v22
    v_dot2c_f32_bf16 v4, v79, v15
    v_dot2c_f32_bf16 v5, v79, v23
    v_dot2c_f32_bf16 v6, v87, v15
    v_dot2c_f32_bf16 v7, v87, v23
    s_nop 0
    v_add_f32_dpp v4, v5, v4 row_ror:8 row_mask:0xf bank_mask:0xf
    s_nop 0
    v_add_f32_dpp v6, v7, v6 row_ror:8 row_mask:0xf bank_mask:0xf
    v_add_f32_dpp v4, v4, v4 row_half_mirror row_mask:0xf bank_mask:0xf
    s_nop 0
    v_add_f32_dpp v6, v6, v6 row_half_mirror row_mask:0xf bank_mask:0xf
    v_add_f32_dpp v4, v4, v4 quad_perm:[1,0,3,2] row_mask:0xf bank_mask:0xf
    s_nop 0
    v_add_f32_dpp v6, v6, v6 quad_perm:[1,0,3,2] row_mask:0xf bank_mask:0xf
    v_add_f32_dpp v4, v4, v4 quad_perm:[2,3,0,1] row_mask:0xf bank_mask:0xf
    s_nop 0
    v_add_f32_dpp v6, v6, v6 quad_perm:[2,3,0,1] row_mask:0xf bank_mask:0xf
    v_cvt_pk_bf16_f32 v58, 0, v4
    v_cvt_pk_bf16_f32 v59, 0, v6
    v_max3_f32 v1, v1, v58, v59
    s_waitcnt vmcnt(4)
    buffer_load_dwordx4 v[192:195], v0, s[40:43], s6 offen offset:2048 nt
    s_waitcnt vmcnt(4)
    buffer_load_dwordx4 v[196:199], v0, s[40:43], s6 offen offset:2304 nt
    v_dot2_f32_bf16 v4, v96, v8, 0
    v_dot2_f32_bf16 v5, v96, v16, 0
    v_dot2_f32_bf16 v6, v104, v8, 0
    v_dot2_f32_bf16 v7, v104, v16, 0
    v_dot2c_f32_bf16 v4, v97, v9
    v_dot2c_f32_bf16 v5, v97, v17
    v_dot2c_f32_bf16 v6, v105, v9
    v_dot2c_f32_bf16 v7, v105, v17
    v_dot2c_f32_bf16 v4, v98, v10
    v_dot2c_f32_bf16 v5, v98, v18
    v_dot2c_f32_bf16 v6, v106, v10
    v_dot2c_f32_bf16 v7, v106, v18
    v_dot2c_f32_bf16 v4, v99, v11
    v_dot2c_f32_bf16 v5, v99, v19
    v_dot2c_f32_bf16 v6, v107, v11
    v_dot2c_f32_bf16 v7, v107, v19
    v_dot2c_f32_bf16 v4, v100, v12
    v_dot2c_f32_bf16 v5, v100, v20
    v_dot2c_f32_bf16 v6, v108, v12
    v_dot2c_f32_bf16 v7, v108, v20
    v_dot2c_f32_bf16 v4, v101, v13
    v_dot2c_f32_bf16 v5, v101, v21
    v_dot2c_f32_bf16 v6, v109, v13
    v_dot2c_f32_bf16 v7, v109, v21
    v_dot2c_f32_bf16 v4, v102, v14
    v_dot2c_f32_bf16 v5, v102, v22
    v_dot2c_f32_bf16 v6, v110, v14
    v_dot2c_f32_bf16 v7, v110, v22
    v_dot2c_f32_bf16 v4, v103, v15
    v_dot2c_f32_bf16 v5, v103, v23
    v_dot2c_f32_bf16 v6, v111, v15
    v_dot2c_f32_bf16 v7, v111, v23
    s_nop 0
    v_add_f32_dpp v4, v5, v4 row_ror:8 row_mask:0xf bank_mask:0xf
    s_nop 0
    v_add_f32_dpp v6, v7, v6 row_ror:8 row_mask:0xf bank_mask:0xf
    v_add_f32_dpp v4, v4, v4 row_half_mirror row_mask:0xf bank_mask:0xf
    s_nop 0
    v_add_f32_dpp v6, v6, v6 row_half_mirror row_mask:0xf bank_mask:0xf
    v_add_f32_dpp v4, v4, v4 quad_perm:[1,0,3,2] row_mask:0xf bank_mask:0xf
    s_nop 0
    v_add_f32_dpp v6, v6, v6 quad_perm:[1,0,3,2] row_mask:0xf bank_mask:0xf
    v_add_f32_dpp v4, v4, v4 quad_perm:[2,3,0,1] row_mask:0xf bank_mask:0xf
    s_nop 0
    v_add_f32_dpp v6, v6, v6 quad_perm:[2,3,0,1] row_mask:0xf bank_mask:0xf
    v_cvt_pk_bf16_f32 v60, 0, v4
    v_cvt_pk_bf16_f32 v61, 0, v6
    v_max3_f32 v1, v1, v60, v61
    s_xor_b32 s6, s7, 0x440000
    s_waitcnt vmcnt(4)
    buffer_load_dwordx4 v[200:203], v0, s[40:43], s6 offen offset:0 nt
    s_waitcnt vmcnt(4)
    buffer_load_dwordx4 v[204:207], v0, s[40:43], s6 offen offset:256 nt
    v_dot2_f32_bf16 v4, v112, v8, 0
    v_dot2_f32_bf16 v5, v112, v16, 0
    v_dot2_f32_bf16 v6, v120, v8, 0
    v_dot2_f32_bf16 v7, v120, v16, 0
    v_dot2c_f32_bf16 v4, v113, v9
    v_dot2c_f32_bf16 v5, v113, v17
    v_dot2c_f32_bf16 v6, v121, v9
    v_dot2c_f32_bf16 v7, v121, v17
    v_dot2c_f32_bf16 v4, v114, v10
    v_dot2c_f32_bf16 v5, v114, v18
    v_dot2c_f32_bf16 v6, v122, v10
    v_dot2c_f32_bf16 v7, v122, v18
    v_dot2c_f32_bf16 v4, v115, v11
    v_dot2c_f32_bf16 v5, v115, v19
    v_dot2c_f32_bf16 v6, v123, v11
    v_dot2c_f32_bf16 v7, v123, v19
    v_dot2c_f32_bf16 v4, v116, v12
    v_dot2c_f32_bf16 v5, v116, v20
    v_dot2c_f32_bf16 v6, v124, v12
    v_dot2c_f32_bf16 v7, v124, v20
    v_dot2c_f32_bf16 v4, v117, v13
    v_dot2c_f32_bf16 v5, v117, v21
    v_dot2c_f32_bf16 v6, v125, v13
    v_dot2c_f32_bf16 v7, v125, v21
    v_dot2c_f32_bf16 v4, v118, v14
    v_dot2c_f32_bf16 v5, v118, v22
    v_dot2c_f32_bf16 v6, v126, v14
    v_dot2c_f32_bf16 v7, v126, v22
    v_dot2c_f32_bf16 v4, v119, v15
    v_dot2c_f32_bf16 v5, v119, v23
    v_dot2c_f32_bf16 v6, v127, v15
    v_dot2c_f32_bf16 v7, v127, v23
    s_nop 0
    v_add_f32_dpp v4, v5, v4 row_ror:8 row_mask:0xf bank_mask:0xf
    s_nop 0
    v_add_f32_dpp v6, v7, v6 row_ror:8 row_mask:0xf bank_mask:0xf
    v_add_f32_dpp v4, v4, v4 row_half_mirror row_mask:0xf bank_mask:0xf
    s_nop 0
    v_add_f32_dpp v6, v6, v6 row_half_mirror row_mask:0xf bank_mask:0xf
    v_add_f32_dpp v4, v4, v4 quad_perm:[1,0,3,2] row_mask:0xf bank_mask:0xf
    s_nop 0
    v_add_f32_dpp v6, v6, v6 quad_perm:[1,0,3,2] row_mask:0xf bank_mask:0xf
    v_add_f32_dpp v4, v4, v4 quad_perm:[2,3,0,1] row_mask:0xf bank_mask:0xf
    s_nop 0
    v_add_f32_dpp v6, v6, v6 quad_perm:[2,3,0,1] row_mask:0xf bank_mask:0xf
    v_cvt_pk_bf16_f32 v62, 0, v4
    v_cvt_pk_bf16_f32 v63, 0, v6
    v_max3_f32 v1, v1, v62, v63
    s_waitcnt vmcnt(4)
    buffer_load_dwordx4 v[208:211], v0, s[40:43], s6 offen offset:2048 nt
    s_waitcnt vmcnt(4)
    buffer_load_dwordx4 v[212:215], v0, s[40:43], s6 offen offset:2304 nt
    v_dot2_f32_bf16 v4, v128, v8, 0
    v_dot2_f32_bf16 v5, v128, v16, 0
    v_dot2_f32_bf16 v6, v136, v8, 0
    v_dot2_f32_bf16 v7, v136, v16, 0
    v_dot2c_f32_bf16 v4, v129, v9
    v_dot2c_f32_bf16 v5, v129, v17
    v_dot2c_f32_bf16 v6, v137, v9
    v_dot2c_f32_bf16 v7, v137, v17
    v_dot2c_f32_bf16 v4, v130, v10
    v_dot2c_f32_bf16 v5, v130, v18
    v_dot2c_f32_bf16 v6, v138, v10
    v_dot2c_f32_bf16 v7, v138, v18
    v_dot2c_f32_bf16 v4, v131, v11
    v_dot2c_f32_bf16 v5, v131, v19
    v_dot2c_f32_bf16 v6, v139, v11
    v_dot2c_f32_bf16 v7, v139, v19
    v_dot2c_f32_bf16 v4, v132, v12
    v_dot2c_f32_bf16 v5, v132, v20
    v_dot2c_f32_bf16 v6, v140, v12
    v_dot2c_f32_bf16 v7, v140, v20
    v_dot2c_f32_bf16 v4, v133, v13
    v_dot2c_f32_bf16 v5, v133, v21
    v_dot2c_f32_bf16 v6, v141, v13
    v_dot2c_f32_bf16 v7, v141, v21
    v_dot2c_f32_bf16 v4, v134, v14
    v_dot2c_f32_bf16 v5, v134, v22
    v_dot2c_f32_bf16 v6, v142, v14
    v_dot2c_f32_bf16 v7, v142, v22
    v_dot2c_f32_bf16 v4, v135, v15
    v_dot2c_f32_bf16 v5, v135, v23
    v_dot2c_f32_bf16 v6, v143, v15
    v_dot2c_f32_bf16 v7, v143, v23
    s_nop 0
    v_add_f32_dpp v4, v5, v4 row_ror:8 row_mask:0xf bank_mask:0xf
    s_nop 0
    v_add_f32_dpp v6, v7, v6 row_ror:8 row_mask:0xf bank_mask:0xf
    v_add_f32_dpp v4, v4, v4 row_half_mirror row_mask:0xf bank_mask:0xf
    s_nop 0
    v_add_f32_dpp v6, v6, v6 row_half_mirror row_mask:0xf bank_mask:0xf
    v_add_f32_dpp v4, v4, v4 quad_perm:[1,0,3,2] row_mask:0xf bank_mask:0xf
    s_nop 0
    v_add_f32_dpp v6, v6, v6 quad_perm:[1,0,3,2] row_mask:0xf bank_mask:0xf
    v_add_f32_dpp v4, v4, v4 quad_perm:[2,3,0,1] row_mask:0xf bank_mask:0xf
    s_nop 0
    v_add_f32_dpp v6, v6, v6 quad_perm:[2,3,0,1] row_mask:0xf bank_mask:0xf
    v_cvt_pk_bf16_f32 v128, 0, v4
    v_cvt_pk_bf16_f32 v129, 0, v6
    v_max3_f32 v1, v1, v128, v129
    s_xor_b32 s6, s7, 0xc40000
    s_waitcnt vmcnt(4)
    buffer_load_dwordx4 v[224:227], v0, s[40:43], s6 offen offset:0 nt
    s_waitcnt vmcnt(4)
    buffer_load_dwordx4 v[228:231], v0, s[40:43], s6 offen offset:256 nt
    v_dot2_f32_bf16 v4, v144, v8, 0
    v_dot2_f32_bf16 v5, v144, v16, 0
    v_dot2_f32_bf16 v6, v160, v8, 0
    v_dot2_f32_bf16 v7, v160, v16, 0
    v_dot2c_f32_bf16 v4, v145, v9
    v_dot2c_f32_bf16 v5, v145, v17
    v_dot2c_f32_bf16 v6, v161, v9
    v_dot2c_f32_bf16 v7, v161, v17
    v_dot2c_f32_bf16 v4, v146, v10
    v_dot2c_f32_bf16 v5, v146, v18
    v_dot2c_f32_bf16 v6, v162, v10
    v_dot2c_f32_bf16 v7, v162, v18
    v_dot2c_f32_bf16 v4, v147, v11
    v_dot2c_f32_bf16 v5, v147, v19
    v_dot2c_f32_bf16 v6, v163, v11
    v_dot2c_f32_bf16 v7, v163, v19
    v_dot2c_f32_bf16 v4, v148, v12
    v_dot2c_f32_bf16 v5, v148, v20
    v_dot2c_f32_bf16 v6, v164, v12
    v_dot2c_f32_bf16 v7, v164, v20
    v_dot2c_f32_bf16 v4, v149, v13
    v_dot2c_f32_bf16 v5, v149, v21
    v_dot2c_f32_bf16 v6, v165, v13
    v_dot2c_f32_bf16 v7, v165, v21
    v_dot2c_f32_bf16 v4, v150, v14
    v_dot2c_f32_bf16 v5, v150, v22
    v_dot2c_f32_bf16 v6, v166, v14
    v_dot2c_f32_bf16 v7, v166, v22
    v_dot2c_f32_bf16 v4, v151, v15
    v_dot2c_f32_bf16 v5, v151, v23
    v_dot2c_f32_bf16 v6, v167, v15
    v_dot2c_f32_bf16 v7, v167, v23
    s_nop 0
    v_add_f32_dpp v4, v5, v4 row_ror:8 row_mask:0xf bank_mask:0xf
    s_nop 0
    v_add_f32_dpp v6, v7, v6 row_ror:8 row_mask:0xf bank_mask:0xf
    v_add_f32_dpp v4, v4, v4 row_half_mirror row_mask:0xf bank_mask:0xf
    s_nop 0
    v_add_f32_dpp v6, v6, v6 row_half_mirror row_mask:0xf bank_mask:0xf
    v_add_f32_dpp v4, v4, v4 quad_perm:[1,0,3,2] row_mask:0xf bank_mask:0xf
    s_nop 0
    v_add_f32_dpp v6, v6, v6 quad_perm:[1,0,3,2] row_mask:0xf bank_mask:0xf
    v_add_f32_dpp v4, v4, v4 quad_perm:[2,3,0,1] row_mask:0xf bank_mask:0xf
    s_nop 0
    v_add_f32_dpp v6, v6, v6 quad_perm:[2,3,0,1] row_mask:0xf bank_mask:0xf
    v_cvt_pk_bf16_f32 v130, 0, v4
    v_cvt_pk_bf16_f32 v131, 0, v6
    v_max3_f32 v1, v1, v130, v131
    s_waitcnt vmcnt(4)
    buffer_load_dwordx4 v[232:235], v0, s[40:43], s6 offen offset:2048 nt
    s_waitcnt vmcnt(4)
    buffer_load_dwordx4 v[236:239], v0, s[40:43], s6 offen offset:2304 nt
    v_dot2_f32_bf16 v4, v168, v8, 0
    v_dot2_f32_bf16 v5, v168, v16, 0
    v_dot2_f32_bf16 v6, v176, v8, 0
    v_dot2_f32_bf16 v7, v176, v16, 0
    v_dot2c_f32_bf16 v4, v169, v9
    v_dot2c_f32_bf16 v5, v169, v17
    v_dot2c_f32_bf16 v6, v177, v9
    v_dot2c_f32_bf16 v7, v177, v17
    v_dot2c_f32_bf16 v4, v170, v10
    v_dot2c_f32_bf16 v5, v170, v18
    v_dot2c_f32_bf16 v6, v178, v10
    v_dot2c_f32_bf16 v7, v178, v18
    v_dot2c_f32_bf16 v4, v171, v11
    v_dot2c_f32_bf16 v5, v171, v19
    v_dot2c_f32_bf16 v6, v179, v11
    v_dot2c_f32_bf16 v7, v179, v19
    v_dot2c_f32_bf16 v4, v172, v12
    v_dot2c_f32_bf16 v5, v172, v20
    v_dot2c_f32_bf16 v6, v180, v12
    v_dot2c_f32_bf16 v7, v180, v20
    v_dot2c_f32_bf16 v4, v173, v13
    v_dot2c_f32_bf16 v5, v173, v21
    v_dot2c_f32_bf16 v6, v181, v13
    v_dot2c_f32_bf16 v7, v181, v21
    v_dot2c_f32_bf16 v4, v174, v14
    v_dot2c_f32_bf16 v5, v174, v22
    v_dot2c_f32_bf16 v6, v182, v14
    v_dot2c_f32_bf16 v7, v182, v22
    v_dot2c_f32_bf16 v4, v175, v15
    v_dot2c_f32_bf16 v5, v175, v23
    v_dot2c_f32_bf16 v6, v183, v15
    v_dot2c_f32_bf16 v7, v183, v23
    s_nop 0
    v_add_f32_dpp v4, v5, v4 row_ror:8 row_mask:0xf bank_mask:0xf
    s_nop 0
    v_add_f32_dpp v6, v7, v6 row_ror:8 row_mask:0xf bank_mask:0xf
    v_add_f32_dpp v4, v4, v4 row_half_mirror row_mask:0xf bank_mask:0xf
    s_nop 0
    v_add_f32_dpp v6, v6, v6 row_half_mirror row_mask:0xf bank_mask:0xf
    v_add_f32_dpp v4, v4, v4 quad_perm:[1,0,3,2] row_mask:0xf bank_mask:0xf
    s_nop 0
    v_add_f32_dpp v6, v6, v6 quad_perm:[1,0,3,2] row_mask:0xf bank_mask:0xf
    v_add_f32_dpp v4, v4, v4 quad_perm:[2,3,0,1] row_mask:0xf bank_mask:0xf
    s_nop 0
    v_add_f32_dpp v6, v6, v6 quad_perm:[2,3,0,1] row_mask:0xf bank_mask:0xf
    v_cvt_pk_bf16_f32 v132, 0, v4
    v_cvt_pk_bf16_f32 v133, 0, v6
    v_max3_f32 v1, v1, v132, v133
    s_xor_b32 s6, s7, 0x450000
    s_waitcnt vmcnt(4)
    buffer_load_dwordx4 v[240:243], v0, s[40:43], s6 offen offset:0 nt
    s_waitcnt vmcnt(4)
    buffer_load_dwordx4 v[244:247], v0, s[40:43], s6 offen offset:256 nt
    v_dot2_f32_bf16 v4, v184, v8, 0
    v_dot2_f32_bf16 v5, v184, v16, 0
    v_dot2_f32_bf16 v6, v192, v8, 0
    v_dot2_f32_bf16 v7, v192, v16, 0
    v_dot2c_f32_bf16 v4, v185, v9
    v_dot2c_f32_bf16 v5, v185, v17
    v_dot2c_f32_bf16 v6, v193, v9
    v_dot2c_f32_bf16 v7, v193, v17
    v_dot2c_f32_bf16 v4, v186, v10
    v_dot2c_f32_bf16 v5, v186, v18
    v_dot2c_f32_bf16 v6, v194, v10
    v_dot2c_f32_bf16 v7, v194, v18
    v_dot2c_f32_bf16 v4, v187, v11
    v_dot2c_f32_bf16 v5, v187, v19
    v_dot2c_f32_bf16 v6, v195, v11
    v_dot2c_f32_bf16 v7, v195, v19
    v_dot2c_f32_bf16 v4, v188, v12
    v_dot2c_f32_bf16 v5, v188, v20
    v_dot2c_f32_bf16 v6, v196, v12
    v_dot2c_f32_bf16 v7, v196, v20
    v_dot2c_f32_bf16 v4, v189, v13
    v_dot2c_f32_bf16 v5, v189, v21
    v_dot2c_f32_bf16 v6, v197, v13
    v_dot2c_f32_bf16 v7, v197, v21
    v_dot2c_f32_bf16 v4, v190, v14
    v_dot2c_f32_bf16 v5, v190, v22
    v_dot2c_f32_bf16 v6, v198, v14
    v_dot2c_f32_bf16 v7, v198, v22
    v_dot2c_f32_bf16 v4, v191, v15
    v_dot2c_f32_bf16 v5, v191, v23
    v_dot2c_f32_bf16 v6, v199, v15
    v_dot2c_f32_bf16 v7, v199, v23
    s_nop 0
    v_add_f32_dpp v4, v5, v4 row_ror:8 row_mask:0xf bank_mask:0xf
    s_nop 0
    v_add_f32_dpp v6, v7, v6 row_ror:8 row_mask:0xf bank_mask:0xf
    v_add_f32_dpp v4, v4, v4 row_half_mirror row_mask:0xf bank_mask:0xf
    s_nop 0
    v_add_f32_dpp v6, v6, v6 row_half_mirror row_mask:0xf bank_mask:0xf
    v_add_f32_dpp v4, v4, v4 quad_perm:[1,0,3,2] row_mask:0xf bank_mask:0xf
    s_nop 0
    v_add_f32_dpp v6, v6, v6 quad_perm:[1,0,3,2] row_mask:0xf bank_mask:0xf
    v_add_f32_dpp v4, v4, v4 quad_perm:[2,3,0,1] row_mask:0xf bank_mask:0xf
    s_nop 0
    v_add_f32_dpp v6, v6, v6 quad_perm:[2,3,0,1] row_mask:0xf bank_mask:0xf
    v_cvt_pk_bf16_f32 v134, 0, v4
    v_cvt_pk_bf16_f32 v135, 0, v6
    v_max3_f32 v1, v1, v134, v135
    s_waitcnt vmcnt(4)
    buffer_load_dwordx4 v[248:251], v0, s[40:43], s6 offen offset:2048 nt
    s_waitcnt vmcnt(4)
    buffer_load_dwordx4 v[252:255], v0, s[40:43], s6 offen offset:2304 nt
    v_dot2_f32_bf16 v4, v200, v8, 0
    v_dot2_f32_bf16 v5, v200, v16, 0
    v_dot2_f32_bf16 v6, v208, v8, 0
    v_dot2_f32_bf16 v7, v208, v16, 0
    v_dot2c_f32_bf16 v4, v201, v9
    v_dot2c_f32_bf16 v5, v201, v17
    v_dot2c_f32_bf16 v6, v209, v9
    v_dot2c_f32_bf16 v7, v209, v17
    v_dot2c_f32_bf16 v4, v202, v10
    v_dot2c_f32_bf16 v5, v202, v18
    v_dot2c_f32_bf16 v6, v210, v10
    v_dot2c_f32_bf16 v7, v210, v18
    v_dot2c_f32_bf16 v4, v203, v11
    v_dot2c_f32_bf16 v5, v203, v19
    v_dot2c_f32_bf16 v6, v211, v11
    v_dot2c_f32_bf16 v7, v211, v19
    v_dot2c_f32_bf16 v4, v204, v12
    v_dot2c_f32_bf16 v5, v204, v20
    v_dot2c_f32_bf16 v6, v212, v12
    v_dot2c_f32_bf16 v7, v212, v20
    v_dot2c_f32_bf16 v4, v205, v13
    v_dot2c_f32_bf16 v5, v205, v21
    v_dot2c_f32_bf16 v6, v213, v13
    v_dot2c_f32_bf16 v7, v213, v21
    v_dot2c_f32_bf16 v4, v206, v14
    v_dot2c_f32_bf16 v5, v206, v22
    v_dot2c_f32_bf16 v6, v214, v14
    v_dot2c_f32_bf16 v7, v214, v22
    v_dot2c_f32_bf16 v4, v207, v15
    v_dot2c_f32_bf16 v5, v207, v23
    v_dot2c_f32_bf16 v6, v215, v15
    v_dot2c_f32_bf16 v7, v215, v23
    s_nop 0
    v_add_f32_dpp v4, v5, v4 row_ror:8 row_mask:0xf bank_mask:0xf
    s_nop 0
    v_add_f32_dpp v6, v7, v6 row_ror:8 row_mask:0xf bank_mask:0xf
    v_add_f32_dpp v4, v4, v4 row_half_mirror row_mask:0xf bank_mask:0xf
    s_nop 0
    v_add_f32_dpp v6, v6, v6 row_half_mirror row_mask:0xf bank_mask:0xf
    v_add_f32_dpp v4, v4, v4 quad_perm:[1,0,3,2] row_mask:0xf bank_mask:0xf
    s_nop 0
    v_add_f32_dpp v6, v6, v6 quad_perm:[1,0,3,2] row_mask:0xf bank_mask:0xf
    v_add_f32_dpp v4, v4, v4 quad_perm:[2,3,0,1] row_mask:0xf bank_mask:0xf
    s_nop 0
    v_add_f32_dpp v6, v6, v6 quad_perm:[2,3,0,1] row_mask:0xf bank_mask:0xf
    v_cvt_pk_bf16_f32 v200, 0, v4
    v_cvt_pk_bf16_f32 v201, 0, v6
    v_max3_f32 v1, v1, v200, v201
    s_xor_b32 s6, s7, 0xc50000
    s_waitcnt vmcnt(4)
    buffer_load_dwordx4 v[32:35], v0, s[40:43], s6 offen offset:0 nt
    s_waitcnt vmcnt(4)
    buffer_load_dwordx4 v[36:39], v0, s[40:43], s6 offen offset:256 nt
    v_dot2_f32_bf16 v4, v224, v8, 0
    v_dot2_f32_bf16 v5, v224, v16, 0
    v_dot2_f32_bf16 v6, v232, v8, 0
    v_dot2_f32_bf16 v7, v232, v16, 0
    v_dot2c_f32_bf16 v4, v225, v9
    v_dot2c_f32_bf16 v5, v225, v17
    v_dot2c_f32_bf16 v6, v233, v9
    v_dot2c_f32_bf16 v7, v233, v17
    v_dot2c_f32_bf16 v4, v226, v10
    v_dot2c_f32_bf16 v5, v226, v18
    v_dot2c_f32_bf16 v6, v234, v10
    v_dot2c_f32_bf16 v7, v234, v18
    v_dot2c_f32_bf16 v4, v227, v11
    v_dot2c_f32_bf16 v5, v227, v19
    v_dot2c_f32_bf16 v6, v235, v11
    v_dot2c_f32_bf16 v7, v235, v19
    v_dot2c_f32_bf16 v4, v228, v12
    v_dot2c_f32_bf16 v5, v228, v20
    v_dot2c_f32_bf16 v6, v236, v12
    v_dot2c_f32_bf16 v7, v236, v20
    v_dot2c_f32_bf16 v4, v229, v13
    v_dot2c_f32_bf16 v5, v229, v21
    v_dot2c_f32_bf16 v6, v237, v13
    v_dot2c_f32_bf16 v7, v237, v21
    v_dot2c_f32_bf16 v4, v230, v14
    v_dot2c_f32_bf16 v5, v230, v22
    v_dot2c_f32_bf16 v6, v238, v14
    v_dot2c_f32_bf16 v7, v238, v22
    v_dot2c_f32_bf16 v4, v231, v15
    v_dot2c_f32_bf16 v5, v231, v23
    v_dot2c_f32_bf16 v6, v239, v15
    v_dot2c_f32_bf16 v7, v239, v23
    s_nop 0
    v_add_f32_dpp v4, v5, v4 row_ror:8 row_mask:0xf bank_mask:0xf
    s_nop 0
    v_add_f32_dpp v6, v7, v6 row_ror:8 row_mask:0xf bank_mask:0xf
    v_add_f32_dpp v4, v4, v4 row_half_mirror row_mask:0xf bank_mask:0xf
    s_nop 0
    v_add_f32_dpp v6, v6, v6 row_half_mirror row_mask:0xf bank_mask:0xf
    v_add_f32_dpp v4, v4, v4 quad_perm:[1,0,3,2] row_mask:0xf bank_mask:0xf
    s_nop 0
    v_add_f32_dpp v6, v6, v6 quad_perm:[1,0,3,2] row_mask:0xf bank_mask:0xf
    v_add_f32_dpp v4, v4, v4 quad_perm:[2,3,0,1] row_mask:0xf bank_mask:0xf
    s_nop 0
    v_add_f32_dpp v6, v6, v6 quad_perm:[2,3,0,1] row_mask:0xf bank_mask:0xf
    v_cvt_pk_bf16_f32 v202, 0, v4
    v_cvt_pk_bf16_f32 v203, 0, v6
    v_max3_f32 v1, v1, v202, v203
    s_waitcnt vmcnt(4)
    buffer_load_dwordx4 v[40:43], v0, s[40:43], s6 offen offset:2048 nt
    s_waitcnt vmcnt(4)
    buffer_load_dwordx4 v[44:47], v0, s[40:43], s6 offen offset:2304 nt
    s_xor_b32 s6, s7, 0x441000
    s_waitcnt vmcnt(4)
    buffer_load_dwordx4 v[48:51], v0, s[40:43], s6 offen offset:0 nt
    s_waitcnt vmcnt(4)
    buffer_load_dwordx4 v[52:55], v0, s[40:43], s6 offen offset:256 nt
    v_dot2_f32_bf16 v4, v240, v8, 0
    v_dot2_f32_bf16 v5, v240, v16, 0
    v_dot2_f32_bf16 v6, v248, v8, 0
    v_dot2_f32_bf16 v7, v248, v16, 0
    v_dot2c_f32_bf16 v4, v241, v9
    v_dot2c_f32_bf16 v5, v241, v17
    v_dot2c_f32_bf16 v6, v249, v9
    v_dot2c_f32_bf16 v7, v249, v17
    v_dot2c_f32_bf16 v4, v242, v10
    v_dot2c_f32_bf16 v5, v242, v18
    v_dot2c_f32_bf16 v6, v250, v10
    v_dot2c_f32_bf16 v7, v250, v18
    v_dot2c_f32_bf16 v4, v243, v11
    v_dot2c_f32_bf16 v5, v243, v19
    v_dot2c_f32_bf16 v6, v251, v11
    v_dot2c_f32_bf16 v7, v251, v19
    v_dot2c_f32_bf16 v4, v244, v12
    v_dot2c_f32_bf16 v5, v244, v20
    v_dot2c_f32_bf16 v6, v252, v12
    v_dot2c_f32_bf16 v7, v252, v20
    v_dot2c_f32_bf16 v4, v245, v13
    v_dot2c_f32_bf16 v5, v245, v21
    v_dot2c_f32_bf16 v6, v253, v13
    v_dot2c_f32_bf16 v7, v253, v21
    v_dot2c_f32_bf16 v4, v246, v14
    v_dot2c_f32_bf16 v5, v246, v22
    v_dot2c_f32_bf16 v6, v254, v14
    v_dot2c_f32_bf16 v7, v254, v22
    v_dot2c_f32_bf16 v4, v247, v15
    v_dot2c_f32_bf16 v5, v247, v23
    v_dot2c_f32_bf16 v6, v255, v15
    v_dot2c_f32_bf16 v7, v255, v23
    s_nop 0
    v_add_f32_dpp v4, v5, v4 row_ror:8 row_mask:0xf bank_mask:0xf
    s_nop 0
    v_add_f32_dpp v6, v7, v6 row_ror:8 row_mask:0xf bank_mask:0xf
    v_add_f32_dpp v4, v4, v4 row_half_mirror row_mask:0xf bank_mask:0xf
    s_nop 0
    v_add_f32_dpp v6, v6, v6 row_half_mirror row_mask:0xf bank_mask:0xf
    v_add_f32_dpp v4, v4, v4 quad_perm:[1,0,3,2] row_mask:0xf bank_mask:0xf
    s_nop 0
    v_add_f32_dpp v6, v6, v6 quad_perm:[1,0,3,2] row_mask:0xf bank_mask:0xf
    v_add_f32_dpp v4, v4, v4 quad_perm:[2,3,0,1] row_mask:0xf bank_mask:0xf
    s_nop 0
    v_add_f32_dpp v6, v6, v6 quad_perm:[2,3,0,1] row_mask:0xf bank_mask:0xf
    v_cvt_pk_bf16_f32 v204, 0, v4
    v_cvt_pk_bf16_f32 v205, 0, v6
    v_max3_f32 v1, v1, v204, v205
    s_waitcnt vmcnt(4)
    buffer_load_dwordx4 v[64:67], v0, s[40:43], s6 offen offset:2048 nt
    s_waitcnt vmcnt(4)
    buffer_load_dwordx4 v[68:71], v0, s[40:43], s6 offen offset:2304 nt
    s_xor_b32 s6, s7, 0xc41000
    s_waitcnt vmcnt(4)
    buffer_load_dwordx4 v[72:75], v0, s[40:43], s6 offen offset:0 nt
    s_waitcnt vmcnt(4)
    buffer_load_dwordx4 v[76:79], v0, s[40:43], s6 offen offset:256 nt
    v_dot2_f32_bf16 v4, v32, v8, 0
    v_dot2_f32_bf16 v5, v32, v16, 0
    v_dot2_f32_bf16 v6, v40, v8, 0
    v_dot2_f32_bf16 v7, v40, v16, 0
    v_dot2c_f32_bf16 v4, v33, v9
    v_dot2c_f32_bf16 v5, v33, v17
    v_dot2c_f32_bf16 v6, v41, v9
    v_dot2c_f32_bf16 v7, v41, v17
    v_dot2c_f32_bf16 v4, v34, v10
    v_dot2c_f32_bf16 v5, v34, v18
    v_dot2c_f32_bf16 v6, v42, v10
    v_dot2c_f32_bf16 v7, v42, v18
    v_dot2c_f32_bf16 v4, v35, v11
    v_dot2c_f32_bf16 v5, v35, v19
    v_dot2c_f32_bf16 v6, v43, v11
    v_dot2c_f32_bf16 v7, v43, v19
    v_dot2c_f32_bf16 v4, v36, v12
    v_dot2c_f32_bf16 v5, v36, v20
    v_dot2c_f32_bf16 v6, v44, v12
    v_dot2c_f32_bf16 v7, v44, v20
    v_dot2c_f32_bf16 v4, v37, v13
    v_dot2c_f32_bf16 v5, v37, v21
    v_dot2c_f32_bf16 v6, v45, v13
    v_dot2c_f32_bf16 v7, v45, v21
    v_dot2c_f32_bf16 v4, v38, v14
    v_dot2c_f32_bf16 v5, v38, v22
    v_dot2c_f32_bf16 v6, v46, v14
    v_dot2c_f32_bf16 v7, v46, v22
    v_dot2c_f32_bf16 v4, v39, v15
    v_dot2c_f32_bf16 v5, v39, v23
    v_dot2c_f32_bf16 v6, v47, v15
    v_dot2c_f32_bf16 v7, v47, v23
    s_nop 0
    v_add_f32_dpp v4, v5, v4 row_ror:8 row_mask:0xf bank_mask:0xf
    s_nop 0
    v_add_f32_dpp v6, v7, v6 row_ror:8 row_mask:0xf bank_mask:0xf
    v_add_f32_dpp v4, v4, v4 row_half_mirror row_mask:0xf bank_mask:0xf
    s_nop 0
    v_add_f32_dpp v6, v6, v6 row_half_mirror row_mask:0xf bank_mask:0xf
    v_add_f32_dpp v4, v4, v4 quad_perm:[1,0,3,2] row_mask:0xf bank_mask:0xf
    s_nop 0
    v_add_f32_dpp v6, v6, v6 quad_perm:[1,0,3,2] row_mask:0xf bank_mask:0xf
    v_add_f32_dpp v4, v4, v4 quad_perm:[2,3,0,1] row_mask:0xf bank_mask:0xf
    s_nop 0
    v_add_f32_dpp v6, v6, v6 quad_perm:[2,3,0,1] row_mask:0xf bank_mask:0xf
    v_cvt_pk_bf16_f32 v206, 0, v4
    v_cvt_pk_bf16_f32 v207, 0, v6
    v_max3_f32 v1, v1, v206, v207
    s_waitcnt vmcnt(4)
    buffer_load_dwordx4 v[80:83], v0, s[40:43], s6 offen offset:2048 nt
    s_waitcnt vmcnt(4)
    buffer_load_dwordx4 v[84:87], v0, s[40:43], s6 offen offset:2304 nt
    s_xor_b32 s6, s7, 0x451000
    s_waitcnt vmcnt(4)
    buffer_load_dwordx4 v[96:99], v0, s[40:43], s6 offen offset:0 nt
    s_waitcnt vmcnt(4)
    buffer_load_dwordx4 v[100:103], v0, s[40:43], s6 offen offset:256 nt
    v_dot2_f32_bf16 v4, v48, v8, 0
    v_dot2_f32_bf16 v5, v48, v16, 0
    v_dot2_f32_bf16 v6, v64, v8, 0
    v_dot2_f32_bf16 v7, v64, v16, 0
    v_dot2c_f32_bf16 v4, v49, v9
    v_dot2c_f32_bf16 v5, v49, v17
    v_dot2c_f32_bf16 v6, v65, v9
    v_dot2c_f32_bf16 v7, v65, v17
    v_dot2c_f32_bf16 v4, v50, v10
    v_dot2c_f32_bf16 v5, v50, v18
    v_dot2c_f32_bf16 v6, v66, v10
    v_dot2c_f32_bf16 v7, v66, v18
    v_dot2c_f32_bf16 v4, v51, v11
    v_dot2c_f32_bf16 v5, v51, v19
    v_dot2c_f32_bf16 v6, v67, v11
    v_dot2c_f32_bf16 v7, v67, v19
    v_dot2c_f32_bf16 v4, v52, v12
    v_dot2c_f32_bf16 v5, v52, v20
    v_dot2c_f32_bf16 v6, v68, v12
    v_dot2c_f32_bf16 v7, v68, v20
    v_dot2c_f32_bf16 v4, v53, v13
    v_dot2c_f32_bf16 v5, v53, v21
    v_dot2c_f32_bf16 v6, v69, v13
    v_dot2c_f32_bf16 v7, v69, v21
    v_dot2c_f32_bf16 v4, v54, v14
    v_dot2c_f32_bf16 v5, v54, v22
    v_dot2c_f32_bf16 v6, v70, v14
    v_dot2c_f32_bf16 v7, v70, v22
    v_dot2c_f32_bf16 v4, v55, v15
    v_dot2c_f32_bf16 v5, v55, v23
    v_dot2c_f32_bf16 v6, v71, v15
    v_dot2c_f32_bf16 v7, v71, v23
    s_nop 0
    v_add_f32_dpp v4, v5, v4 row_ror:8 row_mask:0xf bank_mask:0xf
    s_nop 0
    v_add_f32_dpp v6, v7, v6 row_ror:8 row_mask:0xf bank_mask:0xf
    v_add_f32_dpp v4, v4, v4 row_half_mirror row_mask:0xf bank_mask:0xf
    s_nop 0
    v_add_f32_dpp v6, v6, v6 row_half_mirror row_mask:0xf bank_mask:0xf
    v_add_f32_dpp v4, v4, v4 quad_perm:[1,0,3,2] row_mask:0xf bank_mask:0xf
    s_nop 0
    v_add_f32_dpp v6, v6, v6 quad_perm:[1,0,3,2] row_mask:0xf bank_mask:0xf
    v_add_f32_dpp v4, v4, v4 quad_perm:[2,3,0,1] row_mask:0xf bank_mask:0xf
    s_nop 0
    v_add_f32_dpp v6, v6, v6 quad_perm:[2,3,0,1] row_mask:0xf bank_mask:0xf
    v_cvt_pk_bf16_f32 v48, 0, v4
    v_cvt_pk_bf16_f32 v49, 0, v6
    v_max3_f32 v1, v1, v48, v49
    s_waitcnt vmcnt(4)
    buffer_load_dwordx4 v[104:107], v0, s[40:43], s6 offen offset:2048 nt
    s_waitcnt vmcnt(4)
    buffer_load_dwordx4 v[108:111], v0, s[40:43], s6 offen offset:2304 nt
    s_xor_b32 s6, s7, 0xc51000
    s_waitcnt vmcnt(4)
    buffer_load_dwordx4 v[112:115], v0, s[40:43], s6 offen offset:0 nt
    s_waitcnt vmcnt(4)
    buffer_load_dwordx4 v[116:119], v0, s[40:43], s6 offen offset:256 nt
    v_dot2_f32_bf16 v4, v72, v8, 0
    v_dot2_f32_bf16 v5, v72, v16, 0
    v_dot2_f32_bf16 v6, v80, v8, 0
    v_dot2_f32_bf16 v7, v80, v16, 0
    v_dot2c_f32_bf16 v4, v73, v9
    v_dot2c_f32_bf16 v5, v73, v17
    v_dot2c_f32_bf16 v6, v81, v9
    v_dot2c_f32_bf16 v7, v81, v17
    v_dot2c_f32_bf16 v4, v74, v10
    v_dot2c_f32_bf16 v5, v74, v18
    v_dot2c_f32_bf16 v6, v82, v10
    v_dot2c_f32_bf16 v7, v82, v18
    v_dot2c_f32_bf16 v4, v75, v11
    v_dot2c_f32_bf16 v5, v75, v19
    v_dot2c_f32_bf16 v6, v83, v11
    v_dot2c_f32_bf16 v7, v83, v19
    v_dot2c_f32_bf16 v4, v76, v12
    v_dot2c_f32_bf16 v5, v76, v20
    v_dot2c_f32_bf16 v6, v84, v12
    v_dot2c_f32_bf16 v7, v84, v20
    v_dot2c_f32_bf16 v4, v77, v13
    v_dot2c_f32_bf16 v5, v77, v21
    v_dot2c_f32_bf16 v6, v85, v13
    v_dot2c_f32_bf16 v7, v85, v21
    v_dot2c_f32_bf16 v4, v78, v14
    v_dot2c_f32_bf16 v5, v78, v22
    v_dot2c_f32_bf16 v6, v86, v14
    v_dot2c_f32_bf16 v7, v86, v22
    v_dot2c_f32_bf16 v4, v79, v15
    v_dot2c_f32_bf16 v5, v79, v23
    v_dot2c_f32_bf16 v6, v87, v15
    v_dot2c_f32_bf16 v7, v87, v23
    s_nop 0
    v_add_f32_dpp v4, v5, v4 row_ror:8 row_mask:0xf bank_mask:0xf
    s_nop 0
    v_add_f32_dpp v6, v7, v6 row_ror:8 row_mask:0xf bank_mask:0xf
    v_add_f32_dpp v4, v4, v4 row_half_mirror row_mask:0xf bank_mask:0xf
    s_nop 0
    v_add_f32_dpp v6, v6, v6 row_half_mirror row_mask:0xf bank_mask:0xf
    v_add_f32_dpp v4, v4, v4 quad_perm:[1,0,3,2] row_mask:0xf bank_mask:0xf
    s_nop 0
    v_add_f32_dpp v6, v6, v6 quad_perm:[1,0,3,2] row_mask:0xf bank_mask:0xf
    v_add_f32_dpp v4, v4, v4 quad_perm:[2,3,0,1] row_mask:0xf bank_mask:0xf
    s_nop 0
    v_add_f32_dpp v6, v6, v6 quad_perm:[2,3,0,1] row_mask:0xf bank_mask:0xf
    v_cvt_pk_bf16_f32 v50, 0, v4
    v_cvt_pk_bf16_f32 v51, 0, v6
    v_max3_f32 v1, v1, v50, v51
    s_waitcnt vmcnt(4)
    buffer_load_dwordx4 v[120:123], v0, s[40:43], s6 offen offset:2048 nt
    s_waitcnt vmcnt(4)
    buffer_load_dwordx4 v[124:127], v0, s[40:43], s6 offen offset:2304 nt
    s_xor_b32 s6, s7, 0x0
    s_waitcnt vmcnt(4)
    buffer_load_dwordx4 v[136:139], v0, s[44:47], s6 offen offset:0 nt
    s_waitcnt vmcnt(4)
    buffer_load_dwordx4 v[140:143], v0, s[44:47], s6 offen offset:256 nt
    v_dot2_f32_bf16 v4, v96, v8, 0
    v_dot2_f32_bf16 v5, v96, v16, 0
    v_dot2_f32_bf16 v6, v104, v8, 0
    v_dot2_f32_bf16 v7, v104, v16, 0
    v_dot2c_f32_bf16 v4, v97, v9
    v_dot2c_f32_bf16 v5, v97, v17
    v_dot2c_f32_bf16 v6, v105, v9
    v_dot2c_f32_bf16 v7, v105, v17
    v_dot2c_f32_bf16 v4, v98, v10
    v_dot2c_f32_bf16 v5, v98, v18
    v_dot2c_f32_bf16 v6, v106, v10
    v_dot2c_f32_bf16 v7, v106, v18
    v_dot2c_f32_bf16 v4, v99, v11
    v_dot2c_f32_bf16 v5, v99, v19
    v_dot2c_f32_bf16 v6, v107, v11
    v_dot2c_f32_bf16 v7, v107, v19
    v_dot2c_f32_bf16 v4, v100, v12
    v_dot2c_f32_bf16 v5, v100, v20
    v_dot2c_f32_bf16 v6, v108, v12
    v_dot2c_f32_bf16 v7, v108, v20
    v_dot2c_f32_bf16 v4, v101, v13
    v_dot2c_f32_bf16 v5, v101, v21
    v_dot2c_f32_bf16 v6, v109, v13
    v_dot2c_f32_bf16 v7, v109, v21
    v_dot2c_f32_bf16 v4, v102, v14
    v_dot2c_f32_bf16 v5, v102, v22
    v_dot2c_f32_bf16 v6, v110, v14
    v_dot2c_f32_bf16 v7, v110, v22
    v_dot2c_f32_bf16 v4, v103, v15
    v_dot2c_f32_bf16 v5, v103, v23
    v_dot2c_f32_bf16 v6, v111, v15
    v_dot2c_f32_bf16 v7, v111, v23
    s_nop 0
    v_add_f32_dpp v4, v5, v4 row_ror:8 row_mask:0xf bank_mask:0xf
    s_nop 0
    v_add_f32_dpp v6, v7, v6 row_ror:8 row_mask:0xf bank_mask:0xf
    v_add_f32_dpp v4, v4, v4 row_half_mirror row_mask:0xf bank_mask:0xf
    s_nop 0
    v_add_f32_dpp v6, v6, v6 row_half_mirror row_mask:0xf bank_mask:0xf
    v_add_f32_dpp v4, v4, v4 quad_perm:[1,0,3,2] row_mask:0xf bank_mask:0xf
    s_nop 0
    v_add_f32_dpp v6, v6, v6 quad_perm:[1,0,3,2] row_mask:0xf bank_mask:0xf
    v_add_f32_dpp v4, v4, v4 quad_perm:[2,3,0,1] row_mask:0xf bank_mask:0xf
    s_nop 0
    v_add_f32_dpp v6, v6, v6 quad_perm:[2,3,0,1] row_mask:0xf bank_mask:0xf
    v_cvt_pk_bf16_f32 v52, 0, v4
    v_cvt_pk_bf16_f32 v53, 0, v6
    v_max3_f32 v1, v1, v52, v53
    s_waitcnt vmcnt(4)
    buffer_load_dwordx4 v[144:147], v0, s[44:47], s6 offen offset:2048 nt
    s_waitcnt vmcnt(4)
    buffer_load_dwordx4 v[148:151], v0, s[44:47], s6 offen offset:2304 nt
    s_xor_b32 s6, s7, 0x800000
    s_waitcnt vmcnt(4)
    buffer_load_dwordx4 v[160:163], v0, s[44:47], s6 offen offset:0 nt
    s_waitcnt vmcnt(4)
    buffer_load_dwordx4 v[164:167], v0, s[44:47], s6 offen offset:256 nt
    v_dot2_f32_bf16 v4, v112, v8, 0
    v_dot2_f32_bf16 v5, v112, v16, 0
    v_dot2_f32_bf16 v6, v120, v8, 0
    v_dot2_f32_bf16 v7, v120, v16, 0
    v_dot2c_f32_bf16 v4, v113, v9
    v_dot2c_f32_bf16 v5, v113, v17
    v_dot2c_f32_bf16 v6, v121, v9
    v_dot2c_f32_bf16 v7, v121, v17
    v_dot2c_f32_bf16 v4, v114, v10
    v_dot2c_f32_bf16 v5, v114, v18
    v_dot2c_f32_bf16 v6, v122, v10
    v_dot2c_f32_bf16 v7, v122, v18
    v_dot2c_f32_bf16 v4, v115, v11
    v_dot2c_f32_bf16 v5, v115, v19
    v_dot2c_f32_bf16 v6, v123, v11
    v_dot2c_f32_bf16 v7, v123, v19
    v_dot2c_f32_bf16 v4, v116, v12
    v_dot2c_f32_bf16 v5, v116, v20
    v_dot2c_f32_bf16 v6, v124, v12
    v_dot2c_f32_bf16 v7, v124, v20
    v_dot2c_f32_bf16 v4, v117, v13
    v_dot2c_f32_bf16 v5, v117, v21
    v_dot2c_f32_bf16 v6, v125, v13
    v_dot2c_f32_bf16 v7, v125, v21
    v_dot2c_f32_bf16 v4, v118, v14
    v_dot2c_f32_bf16 v5, v118, v22
    v_dot2c_f32_bf16 v6, v126, v14
    v_dot2c_f32_bf16 v7, v126, v22
    v_dot2c_f32_bf16 v4, v119, v15
    v_dot2c_f32_bf16 v5, v119, v23
    v_dot2c_f32_bf16 v6, v127, v15
    v_dot2c_f32_bf16 v7, v127, v23
    s_nop 0
    v_add_f32_dpp v4, v5, v4 row_ror:8 row_mask:0xf bank_mask:0xf
    s_nop 0
    v_add_f32_dpp v6, v7, v6 row_ror:8 row_mask:0xf bank_mask:0xf
    v_add_f32_dpp v4, v4, v4 row_half_mirror row_mask:0xf bank_mask:0xf
    s_nop 0
    v_add_f32_dpp v6, v6, v6 row_half_mirror row_mask:0xf bank_mask:0xf
    v_add_f32_dpp v4, v4, v4 quad_perm:[1,0,3,2] row_mask:0xf bank_mask:0xf
    s_nop 0
    v_add_f32_dpp v6, v6, v6 quad_perm:[1,0,3,2] row_mask:0xf bank_mask:0xf
    v_add_f32_dpp v4, v4, v4 quad_perm:[2,3,0,1] row_mask:0xf bank_mask:0xf
    s_nop 0
    v_add_f32_dpp v6, v6, v6 quad_perm:[2,3,0,1] row_mask:0xf bank_mask:0xf
    v_cvt_pk_bf16_f32 v54, 0, v4
    v_cvt_pk_bf16_f32 v55, 0, v6
    v_max3_f32 v1, v1, v54, v55
    v_mov_b32 v4, v1
    s_nop 1
    v_permlane16_swap_b32 v1, v4
    v_max_f32 v1, v1, v4
    v_mov_b32 v4, v1
    s_nop 1
    v_permlane32_swap_b32 v1, v4
    v_max_f32 v1, v1, v4
    s_mov_b32 s48, 0x3db8aa3b
    v_mul_f32 v1, s48, v1
    s_getreg_b32 s49, hwreg(HW_REG_XCC_ID, 0, 4)
    v_and_b32 v1, -16, v1
    v_or_b32 v1, s49, v1
    v_and_b32 v16, 1, v3
    v_lshlrev_b32 v16, 4, v16
    v_mov_b32 v17, 0xffff
    v_lshlrev_b32 v16, v16, v17
    v_bfe_u32 v17, v3, 1, 2
    v_cmp_eq_u32 s[50:51], 0, v17
    s_nop 1
    v_cndmask_b32 v4, 0, v16, s[50:51]
    v_cmp_eq_u32 s[50:51], 1, v17
    s_nop 1
    v_cndmask_b32 v5, 0, v16, s[50:51]
    v_cmp_eq_u32 s[50:51], 2, v17
    s_nop 1
    v_cndmask_b32 v6, 0, v16, s[50:51]
    v_cmp_eq_u32 s[50:51], 3, v17
    s_nop 1
    v_cndmask_b32 v7, 0, v16, s[50:51]
    v_mov_b32 v8, 0
    v_mov_b32 v9, 0
    v_mov_b32 v10, 0
    v_mov_b32 v11, 0
    v_mov_b32 v12, 0
    v_mov_b32 v13, 0
    v_mov_b32 v14, 0
    v_mov_b32 v15, 0
    v_fma_f32 v24, v24, s48, -v1
    v_fma_f32 v25, v25, s48, -v1
    v_exp_f32 v24, v24
    v_exp_f32 v25, v25
    v_add_f32 v2, v2, v24
    v_cvt_pk_bf16_f32 v24, v24, v24
    v_add_f32 v2, v2, v25
    v_cvt_pk_bf16_f32 v25, v25, v25
    v_fma_f32 v26, v26, s48, -v1
    v_fma_f32 v27, v27, s48, -v1
    v_exp_f32 v26, v26
    v_exp_f32 v27, v27
    v_add_f32 v2, v2, v26
    v_cvt_pk_bf16_f32 v26, v26, v26
    v_add_f32 v2, v2, v27
    v_cvt_pk_bf16_f32 v27, v27, v27
    v_fma_f32 v28, v28, s48, -v1
    v_fma_f32 v29, v29, s48, -v1
    v_exp_f32 v28, v28
    v_exp_f32 v29, v29
    v_add_f32 v2, v2, v28
    v_cvt_pk_bf16_f32 v28, v28, v28
    v_add_f32 v2, v2, v29
    v_cvt_pk_bf16_f32 v29, v29, v29
    v_fma_f32 v30, v30, s48, -v1
    v_fma_f32 v31, v31, s48, -v1
    v_exp_f32 v30, v30
    v_exp_f32 v31, v31
    v_add_f32 v2, v2, v30
    v_cvt_pk_bf16_f32 v30, v30, v30
    v_add_f32 v2, v2, v31
    v_cvt_pk_bf16_f32 v31, v31, v31
    s_waitcnt vmcnt(4)
    buffer_load_dwordx4 v[168:171], v0, s[44:47], s6 offen offset:2048 nt
    s_waitcnt vmcnt(4)
    buffer_load_dwordx4 v[172:175], v0, s[44:47], s6 offen offset:2304 nt
    v_fma_f32 v88, v88, s48, -v1
    v_fma_f32 v89, v89, s48, -v1
    v_exp_f32 v88, v88
    v_exp_f32 v89, v89
    v_add_f32 v2, v2, v88
    v_cvt_pk_bf16_f32 v88, v88, v88
    v_add_f32 v2, v2, v89
    v_cvt_pk_bf16_f32 v89, v89, v89
    v_fma_f32 v90, v90, s48, -v1
    v_fma_f32 v91, v91, s48, -v1
    v_exp_f32 v90, v90
    v_exp_f32 v91, v91
    v_add_f32 v2, v2, v90
    v_cvt_pk_bf16_f32 v90, v90, v90
    v_add_f32 v2, v2, v91
    v_cvt_pk_bf16_f32 v91, v91, v91
    v_fma_f32 v92, v92, s48, -v1
    v_fma_f32 v93, v93, s48, -v1
    v_exp_f32 v92, v92
    v_exp_f32 v93, v93
    v_add_f32 v2, v2, v92
    v_cvt_pk_bf16_f32 v92, v92, v92
    v_add_f32 v2, v2, v93
    v_cvt_pk_bf16_f32 v93, v93, v93
    v_fma_f32 v94, v94, s48, -v1
    v_fma_f32 v95, v95, s48, -v1
    v_exp_f32 v94, v94
    v_exp_f32 v95, v95
    v_add_f32 v2, v2, v94
    v_cvt_pk_bf16_f32 v94, v94, v94
    v_add_f32 v2, v2, v95
    v_cvt_pk_bf16_f32 v95, v95, v95
    v_and_b32 v16, v4, v24
    v_and_b32 v17, v5, v24
    v_and_b32 v18, v6, v24
    v_and_b32 v19, v7, v24
    s_nop 1
    v_mfma_f32_16x16x32_bf16 v[8:11], v[16:19], v[136:139], v[8:11]
    v_mfma_f32_16x16x32_bf16 v[12:15], v[16:19], v[140:143], v[12:15]
    s_xor_b32 s6, s7, 0x10000
    s_waitcnt vmcnt(4)
    buffer_load_dwordx4 v[176:179], v0, s[44:47], s6 offen offset:0 nt
    s_waitcnt vmcnt(4)
    buffer_load_dwordx4 v[180:183], v0, s[44:47], s6 offen offset:256 nt
    v_fma_f32 v152, v152, s48, -v1
    v_fma_f32 v153, v153, s48, -v1
    v_exp_f32 v152, v152
    v_exp_f32 v153, v153
    v_add_f32 v2, v2, v152
    v_cvt_pk_bf16_f32 v152, v152, v152
    v_add_f32 v2, v2, v153
    v_cvt_pk_bf16_f32 v153, v153, v153
    v_fma_f32 v154, v154, s48, -v1
    v_fma_f32 v155, v155, s48, -v1
    v_exp_f32 v154, v154
    v_exp_f32 v155, v155
    v_add_f32 v2, v2, v154
    v_cvt_pk_bf16_f32 v154, v154, v154
    v_add_f32 v2, v2, v155
    v_cvt_pk_bf16_f32 v155, v155, v155
    v_fma_f32 v156, v156, s48, -v1
    v_fma_f32 v157, v157, s48, -v1
    v_exp_f32 v156, v156
    v_exp_f32 v157, v157
    v_add_f32 v2, v2, v156
    v_cvt_pk_bf16_f32 v156, v156, v156
    v_add_f32 v2, v2, v157
    v_cvt_pk_bf16_f32 v157, v157, v157
    v_fma_f32 v158, v158, s48, -v1
    v_fma_f32 v159, v159, s48, -v1
    v_exp_f32 v158, v158
    v_exp_f32 v159, v159
    v_add_f32 v2, v2, v158
    v_cvt_pk_bf16_f32 v158, v158, v158
    v_add_f32 v2, v2, v159
    v_cvt_pk_bf16_f32 v159, v159, v159
    v_and_b32 v20, v4, v25
    v_and_b32 v21, v5, v25
    v_and_b32 v22, v6, v25
    v_and_b32 v23, v7, v25
    s_nop 1
    v_mfma_f32_16x16x32_bf16 v[8:11], v[20:23], v[144:147], v[8:11]
    v_mfma_f32_16x16x32_bf16 v[12:15], v[20:23], v[148:151], v[12:15]
    s_waitcnt vmcnt(4)
    buffer_load_dwordx4 v[184:187], v0, s[44:47], s6 offen offset:2048 nt
    s_waitcnt vmcnt(4)
    buffer_load_dwordx4 v[188:191], v0, s[44:47], s6 offen offset:2304 nt
    v_fma_f32 v216, v216, s48, -v1
    v_fma_f32 v217, v217, s48, -v1
    v_exp_f32 v216, v216
    v_exp_f32 v217, v217
    v_add_f32 v2, v2, v216
    v_cvt_pk_bf16_f32 v216, v216, v216
    v_add_f32 v2, v2, v217
    v_cvt_pk_bf16_f32 v217, v217, v217
    v_fma_f32 v218, v218, s48, -v1
    v_fma_f32 v219, v219, s48, -v1
    v_exp_f32 v218, v218
    v_exp_f32 v219, v219
    v_add_f32 v2, v2, v218
    v_cvt_pk_bf16_f32 v218, v218, v218
    v_add_f32 v2, v2, v219
    v_cvt_pk_bf16_f32 v219, v219, v219
    v_fma_f32 v220, v220, s48, -v1
    v_fma_f32 v221, v221, s48, -v1
    v_exp_f32 v220, v220
    v_exp_f32 v221, v221
    v_add_f32 v2, v2, v220
    v_cvt_pk_bf16_f32 v220, v220, v220
    v_add_f32 v2, v2, v221
    v_cvt_pk_bf16_f32 v221, v221, v221
    v_fma_f32 v222, v222, s48, -v1
    v_fma_f32 v223, v223, s48, -v1
    v_exp_f32 v222, v222
    v_exp_f32 v223, v223
    v_add_f32 v2, v2, v222
    v_cvt_pk_bf16_f32 v222, v222, v222
    v_add_f32 v2, v2, v223
    v_cvt_pk_bf16_f32 v223, v223, v223
    v_and_b32 v16, v4, v26
    v_and_b32 v17, v5, v26
    v_and_b32 v18, v6, v26
    v_and_b32 v19, v7, v26
    s_nop 1
    v_mfma_f32_16x16x32_bf16 v[8:11], v[16:19], v[160:163], v[8:11]
    v_mfma_f32_16x16x32_bf16 v[12:15], v[16:19], v[164:167], v[12:15]
    s_xor_b32 s6, s7, 0x810000
    s_waitcnt vmcnt(4)
    buffer_load_dwordx4 v[192:195], v0, s[44:47], s6 offen offset:0 nt
    s_waitcnt vmcnt(4)
    buffer_load_dwordx4 v[196:199], v0, s[44:47], s6 offen offset:256 nt
    v_fma_f32 v56, v56, s48, -v1
    v_fma_f32 v57, v57, s48, -v1
    v_exp_f32 v56, v56
    v_exp_f32 v57, v57
    v_add_f32 v2, v2, v56
    v_cvt_pk_bf16_f32 v56, v56, v56
    v_add_f32 v2, v2, v57
    v_cvt_pk_bf16_f32 v57, v57, v57
    v_fma_f32 v58, v58, s48, -v1
    v_fma_f32 v59, v59, s48, -v1
    v_exp_f32 v58, v58
    v_exp_f32 v59, v59
    v_add_f32 v2, v2, v58
    v_cvt_pk_bf16_f32 v58, v58, v58
    v_add_f32 v2, v2, v59
    v_cvt_pk_bf16_f32 v59, v59, v59
    v_fma_f32 v60, v60, s48, -v1
    v_fma_f32 v61, v61, s48, -v1
    v_exp_f32 v60, v60
    v_exp_f32 v61, v61
    v_add_f32 v2, v2, v60
    v_cvt_pk_bf16_f32 v60, v60, v60
    v_add_f32 v2, v2, v61
    v_cvt_pk_bf16_f32 v61, v61, v61
    v_fma_f32 v62, v62, s48, -v1
    v_fma_f32 v63, v63, s48, -v1
    v_exp_f32 v62, v62
    v_exp_f32 v63, v63
    v_add_f32 v2, v2, v62
    v_cvt_pk_bf16_f32 v62, v62, v62
    v_add_f32 v2, v2, v63
    v_cvt_pk_bf16_f32 v63, v63, v63
    v_and_b32 v20, v4, v27
    v_and_b32 v21, v5, v27
    v_and_b32 v22, v6, v27
    v_and_b32 v23, v7, v27
    s_nop 1
    v_mfma_f32_16x16x32_bf16 v[8:11], v[20:23], v[168:171], v[8:11]
    v_mfma_f32_16x16x32_bf16 v[12:15], v[20:23], v[172:175], v[12:15]
    s_waitcnt vmcnt(4)
    buffer_load_dwordx4 v[208:211], v0, s[44:47], s6 offen offset:2048 nt
    s_waitcnt vmcnt(4)
    buffer_load_dwordx4 v[212:215], v0, s[44:47], s6 offen offset:2304 nt
    v_fma_f32 v128, v128, s48, -v1
    v_fma_f32 v129, v129, s48, -v1
    v_exp_f32 v128, v128
    v_exp_f32 v129, v129
    v_add_f32 v2, v2, v128
    v_cvt_pk_bf16_f32 v128, v128, v128
    v_add_f32 v2, v2, v129
    v_cvt_pk_bf16_f32 v129, v129, v129
    v_fma_f32 v130, v130, s48, -v1
    v_fma_f32 v131, v131, s48, -v1
    v_exp_f32 v130, v130
    v_exp_f32 v131, v131
    v_add_f32 v2, v2, v130
    v_cvt_pk_bf16_f32 v130, v130, v130
    v_add_f32 v2, v2, v131
    v_cvt_pk_bf16_f32 v131, v131, v131
    v_fma_f32 v132, v132, s48, -v1
    v_fma_f32 v133, v133, s48, -v1
    v_exp_f32 v132, v132
    v_exp_f32 v133, v133
    v_add_f32 v2, v2, v132
    v_cvt_pk_bf16_f32 v132, v132, v132
    v_add_f32 v2, v2, v133
    v_cvt_pk_bf16_f32 v133, v133, v133
    v_fma_f32 v134, v134, s48, -v1
    v_fma_f32 v135, v135, s48, -v1
    v_exp_f32 v134, v134
    v_exp_f32 v135, v135
    v_add_f32 v2, v2, v134
    v_cvt_pk_bf16_f32 v134, v134, v134
    v_add_f32 v2, v2, v135
    v_cvt_pk_bf16_f32 v135, v135, v135
    v_and_b32 v16, v4, v28
    v_and_b32 v17, v5, v28
    v_and_b32 v18, v6, v28
    v_and_b32 v19, v7, v28
    s_nop 1
    v_mfma_f32_16x16x32_bf16 v[8:11], v[16:19], v[176:179], v[8:11]
    v_mfma_f32_16x16x32_bf16 v[12:15], v[16:19], v[180:183], v[12:15]
    s_xor_b32 s6, s7, 0x1000
    s_waitcnt vmcnt(4)
    buffer_load_dwordx4 v[224:227], v0, s[44:47], s6 offen offset:0 nt
    s_waitcnt vmcnt(4)
    buffer_load_dwordx4 v[228:231], v0, s[44:47], s6 offen offset:256 nt
    v_fma_f32 v200, v200, s48, -v1
    v_fma_f32 v201, v201, s48, -v1
    v_exp_f32 v200, v200
    v_exp_f32 v201, v201
    v_add_f32 v2, v2, v200
    v_cvt_pk_bf16_f32 v200, v200, v200
    v_add_f32 v2, v2, v201
    v_cvt_pk_bf16_f32 v201, v201, v201
    v_fma_f32 v202, v202, s48, -v1
    v_fma_f32 v203, v203, s48, -v1
    v_exp_f32 v202, v202
    v_exp_f32 v203, v203
    v_add_f32 v2, v2, v202
    v_cvt_pk_bf16_f32 v202, v202, v202
    v_add_f32 v2, v2, v203
    v_cvt_pk_bf16_f32 v203, v203, v203
    v_fma_f32 v204, v204, s48, -v1
    v_fma_f32 v205, v205, s48, -v1
    v_exp_f32 v204, v204
    v_exp_f32 v205, v205
    v_add_f32 v2, v2, v204
    v_cvt_pk_bf16_f32 v204, v204, v204
    v_add_f32 v2, v2, v205
    v_cvt_pk_bf16_f32 v205, v205, v205
    v_fma_f32 v206, v206, s48, -v1
    v_fma_f32 v207, v207, s48, -v1
    v_exp_f32 v206, v206
    v_exp_f32 v207, v207
    v_add_f32 v2, v2, v206
    v_cvt_pk_bf16_f32 v206, v206, v206
    v_add_f32 v2, v2, v207
    v_cvt_pk_bf16_f32 v207, v207, v207
    v_and_b32 v20, v4, v29
    v_and_b32 v21, v5, v29
    v_and_b32 v22, v6, v29
    v_and_b32 v23, v7, v29
    s_nop 1
    v_mfma_f32_16x16x32_bf16 v[8:11], v[20:23], v[184:187], v[8:11]
    v_mfma_f32_16x16x32_bf16 v[12:15], v[20:23], v[188:191], v[12:15]
    s_waitcnt vmcnt(4)
    buffer_load_dwordx4 v[232:235], v0, s[44:47], s6 offen offset:2048 nt
    s_waitcnt vmcnt(4)
    buffer_load_dwordx4 v[236:239], v0, s[44:47], s6 offen offset:2304 nt
    v_fma_f32 v48, v48, s48, -v1
    v_fma_f32 v49, v49, s48, -v1
    v_exp_f32 v48, v48
    v_exp_f32 v49, v49
    v_add_f32 v2, v2, v48
    v_cvt_pk_bf16_f32 v48, v48, v48
    v_add_f32 v2, v2, v49
    v_cvt_pk_bf16_f32 v49, v49, v49
    v_fma_f32 v50, v50, s48, -v1
    v_fma_f32 v51, v51, s48, -v1
    v_exp_f32 v50, v50
    v_exp_f32 v51, v51
    v_add_f32 v2, v2, v50
    v_cvt_pk_bf16_f32 v50, v50, v50
    v_add_f32 v2, v2, v51
    v_cvt_pk_bf16_f32 v51, v51, v51
    v_fma_f32 v52, v52, s48, -v1
    v_fma_f32 v53, v53, s48, -v1
    v_exp_f32 v52, v52
    v_exp_f32 v53, v53
    v_add_f32 v2, v2, v52
    v_cvt_pk_bf16_f32 v52, v52, v52
    v_add_f32 v2, v2, v53
    v_cvt_pk_bf16_f32 v53, v53, v53
    v_fma_f32 v54, v54, s48, -v1
    v_fma_f32 v55, v55, s48, -v1
    v_exp_f32 v54, v54
    v_exp_f32 v55, v55
    v_add_f32 v2, v2, v54
    v_cvt_pk_bf16_f32 v54, v54, v54
    v_add_f32 v2, v2, v55
    v_cvt_pk_bf16_f32 v55, v55, v55
    v_mov_b32 v240, v2
    s_nop 1
    v_permlane16_swap_b32 v2, v240
    v_add_f32 v2, v2, v240
    v_mov_b32 v240, v2
    s_nop 1
    v_permlane32_swap_b32 v2, v240
    v_add_f32 v2, v2, v240
    v_mov_b32 v240, v1
    v_mov_b32 v241, v2
    s_lshl_b32 s49, s3, 3
    v_lshl_add_u32 v242, v3, 2, s49
    v_mov_b32 v243, 0
    v_mov_b32 v244, 1
    s_mov_b64 exec, 0x101
    ds_write_b64 v242, v[240:241] offset:64
    s_mov_b64 exec, 1
    ds_add_u32 v243, v244 offset:4
    s_mov_b64 exec, -1
    v_and_b32 v16, v4, v30
    v_and_b32 v17, v5, v30
    v_and_b32 v18, v6, v30
    v_and_b32 v19, v7, v30
    s_nop 1
    v_mfma_f32_16x16x32_bf16 v[8:11], v[16:19], v[192:195], v[8:11]
    v_mfma_f32_16x16x32_bf16 v[12:15], v[16:19], v[196:199], v[12:15]
    s_xor_b32 s6, s7, 0x801000
    s_waitcnt vmcnt(4)
    buffer_load_dwordx4 v[248:251], v0, s[44:47], s6 offen offset:0 nt
    s_waitcnt vmcnt(4)
    buffer_load_dwordx4 v[252:255], v0, s[44:47], s6 offen offset:256 nt
    v_and_b32 v20, v4, v31
    v_and_b32 v21, v5, v31
    v_and_b32 v22, v6, v31
    v_and_b32 v23, v7, v31
    s_nop 1
    v_mfma_f32_16x16x32_bf16 v[8:11], v[20:23], v[208:211], v[8:11]
    v_mfma_f32_16x16x32_bf16 v[12:15], v[20:23], v[212:215], v[12:15]
    s_waitcnt vmcnt(4)
    buffer_load_dwordx4 v[32:35], v0, s[44:47], s6 offen offset:2048 nt
    s_waitcnt vmcnt(4)
    buffer_load_dwordx4 v[36:39], v0, s[44:47], s6 offen offset:2304 nt
    v_and_b32 v16, v4, v88
    v_and_b32 v17, v5, v88
    v_and_b32 v18, v6, v88
    v_and_b32 v19, v7, v88
    s_nop 1
    v_mfma_f32_16x16x32_bf16 v[8:11], v[16:19], v[224:227], v[8:11]
    v_mfma_f32_16x16x32_bf16 v[12:15], v[16:19], v[228:231], v[12:15]
    s_xor_b32 s6, s7, 0x11000
    s_waitcnt vmcnt(4)
    buffer_load_dwordx4 v[40:43], v0, s[44:47], s6 offen offset:0 nt
    s_waitcnt vmcnt(4)
    buffer_load_dwordx4 v[44:47], v0, s[44:47], s6 offen offset:256 nt
    v_and_b32 v20, v4, v89
    v_and_b32 v21, v5, v89
    v_and_b32 v22, v6, v89
    v_and_b32 v23, v7, v89
    s_nop 1
    v_mfma_f32_16x16x32_bf16 v[8:11], v[20:23], v[232:235], v[8:11]
    v_mfma_f32_16x16x32_bf16 v[12:15], v[20:23], v[236:239], v[12:15]
    s_waitcnt vmcnt(4)
    buffer_load_dwordx4 v[64:67], v0, s[44:47], s6 offen offset:2048 nt
    s_waitcnt vmcnt(4)
    buffer_load_dwordx4 v[68:71], v0, s[44:47], s6 offen offset:2304 nt
    v_and_b32 v16, v4, v90
    v_and_b32 v17, v5, v90
    v_and_b32 v18, v6, v90
    v_and_b32 v19, v7, v90
    s_nop 1
    v_mfma_f32_16x16x32_bf16 v[8:11], v[16:19], v[248:251], v[8:11]
    v_mfma_f32_16x16x32_bf16 v[12:15], v[16:19], v[252:255], v[12:15]
    s_xor_b32 s6, s7, 0x811000
    s_waitcnt vmcnt(4)
    buffer_load_dwordx4 v[72:75], v0, s[44:47], s6 offen offset:0 nt
    s_waitcnt vmcnt(4)
    buffer_load_dwordx4 v[76:79], v0, s[44:47], s6 offen offset:256 nt
    v_and_b32 v20, v4, v91
    v_and_b32 v21, v5, v91
    v_and_b32 v22, v6, v91
    v_and_b32 v23, v7, v91
    s_nop 1
    v_mfma_f32_16x16x32_bf16 v[8:11], v[20:23], v[32:35], v[8:11]
    v_mfma_f32_16x16x32_bf16 v[12:15], v[20:23], v[36:39], v[12:15]
    s_waitcnt vmcnt(4)
    buffer_load_dwordx4 v[80:83], v0, s[44:47], s6 offen offset:2048 nt
    s_waitcnt vmcnt(4)
    buffer_load_dwordx4 v[84:87], v0, s[44:47], s6 offen offset:2304 nt
    v_and_b32 v16, v4, v92
    v_and_b32 v17, v5, v92
    v_and_b32 v18, v6, v92
    v_and_b32 v19, v7, v92
    s_nop 1
    v_mfma_f32_16x16x32_bf16 v[8:11], v[16:19], v[40:43], v[8:11]
    v_mfma_f32_16x16x32_bf16 v[12:15], v[16:19], v[44:47], v[12:15]
    s_xor_b32 s6, s7, 0x400000
    s_waitcnt vmcnt(4)
    buffer_load_dwordx4 v[96:99], v0, s[44:47], s6 offen offset:0 nt
    s_waitcnt vmcnt(4)
    buffer_load_dwordx4 v[100:103], v0, s[44:47], s6 offen offset:256 nt
    v_and_b32 v20, v4, v93
    v_and_b32 v21, v5, v93
    v_and_b32 v22, v6, v93
    v_and_b32 v23, v7, v93
    s_nop 1
    v_mfma_f32_16x16x32_bf16 v[8:11], v[20:23], v[64:67], v[8:11]
    v_mfma_f32_16x16x32_bf16 v[12:15], v[20:23], v[68:71], v[12:15]
    s_waitcnt vmcnt(4)
    buffer_load_dwordx4 v[104:107], v0, s[44:47], s6 offen offset:2048 nt
    s_waitcnt vmcnt(4)
    buffer_load_dwordx4 v[108:111], v0, s[44:47], s6 offen offset:2304 nt
    v_and_b32 v16, v4, v94
    v_and_b32 v17, v5, v94
    v_and_b32 v18, v6, v94
    v_and_b32 v19, v7, v94
    s_nop 1
    v_mfma_f32_16x16x32_bf16 v[8:11], v[16:19], v[72:75], v[8:11]
    v_mfma_f32_16x16x32_bf16 v[12:15], v[16:19], v[76:79], v[12:15]
    s_xor_b32 s6, s7, 0xc00000
    s_waitcnt vmcnt(4)
    buffer_load_dwordx4 v[112:115], v0, s[44:47], s6 offen offset:0 nt
    s_waitcnt vmcnt(4)
    buffer_load_dwordx4 v[116:119], v0, s[44:47], s6 offen offset:256 nt
    v_and_b32 v20, v4, v95
    v_and_b32 v21, v5, v95
    v_and_b32 v22, v6, v95
    v_and_b32 v23, v7, v95
    s_nop 1
    v_mfma_f32_16x16x32_bf16 v[8:11], v[20:23], v[80:83], v[8:11]
    v_mfma_f32_16x16x32_bf16 v[12:15], v[20:23], v[84:87], v[12:15]
    s_waitcnt vmcnt(4)
    buffer_load_dwordx4 v[120:123], v0, s[44:47], s6 offen offset:2048 nt
    s_waitcnt vmcnt(4)
    buffer_load_dwordx4 v[124:127], v0, s[44:47], s6 offen offset:2304 nt
    v_and_b32 v16, v4, v152
    v_and_b32 v17, v5, v152
    v_and_b32 v18, v6, v152
    v_and_b32 v19, v7, v152
    s_nop 1
    v_mfma_f32_16x16x32_bf16 v[8:11], v[16:19], v[96:99], v[8:11]
    v_mfma_f32_16x16x32_bf16 v[12:15], v[16:19], v[100:103], v[12:15]
    s_xor_b32 s6, s7, 0x410000
    s_waitcnt vmcnt(4)
    buffer_load_dwordx4 v[136:139], v0, s[44:47], s6 offen offset:0 nt
    s_waitcnt vmcnt(4)
    buffer_load_dwordx4 v[140:143], v0, s[44:47], s6 offen offset:256 nt
    v_and_b32 v20, v4, v153
    v_and_b32 v21, v5, v153
    v_and_b32 v22, v6, v153
    v_and_b32 v23, v7, v153
    s_nop 1
    v_mfma_f32_16x16x32_bf16 v[8:11], v[20:23], v[104:107], v[8:11]
    v_mfma_f32_16x16x32_bf16 v[12:15], v[20:23], v[108:111], v[12:15]
    s_waitcnt vmcnt(4)
    buffer_load_dwordx4 v[144:147], v0, s[44:47], s6 offen offset:2048 nt
    s_waitcnt vmcnt(4)
    buffer_load_dwordx4 v[148:151], v0, s[44:47], s6 offen offset:2304 nt
    v_and_b32 v16, v4, v154
    v_and_b32 v17, v5, v154
    v_and_b32 v18, v6, v154
    v_and_b32 v19, v7, v154
    s_nop 1
    v_mfma_f32_16x16x32_bf16 v[8:11], v[16:19], v[112:115], v[8:11]
    v_mfma_f32_16x16x32_bf16 v[12:15], v[16:19], v[116:119], v[12:15]
    s_xor_b32 s6, s7, 0xc10000
    s_waitcnt vmcnt(4)
    buffer_load_dwordx4 v[160:163], v0, s[44:47], s6 offen offset:0 nt
    s_waitcnt vmcnt(4)
    buffer_load_dwordx4 v[164:167], v0, s[44:47], s6 offen offset:256 nt
    v_and_b32 v20, v4, v155
    v_and_b32 v21, v5, v155
    v_and_b32 v22, v6, v155
    v_and_b32 v23, v7, v155
    s_nop 1
    v_mfma_f32_16x16x32_bf16 v[8:11], v[20:23], v[120:123], v[8:11]
    v_mfma_f32_16x16x32_bf16 v[12:15], v[20:23], v[124:127], v[12:15]
    s_waitcnt vmcnt(4)
    buffer_load_dwordx4 v[168:171], v0, s[44:47], s6 offen offset:2048 nt
    s_waitcnt vmcnt(4)
    buffer_load_dwordx4 v[172:175], v0, s[44:47], s6 offen offset:2304 nt
    v_and_b32 v16, v4, v156
    v_and_b32 v17, v5, v156
    v_and_b32 v18, v6, v156
    v_and_b32 v19, v7, v156
    s_nop 1
    v_mfma_f32_16x16x32_bf16 v[8:11], v[16:19], v[136:139], v[8:11]
    v_mfma_f32_16x16x32_bf16 v[12:15], v[16:19], v[140:143], v[12:15]
    s_xor_b32 s6, s7, 0x401000
    s_waitcnt vmcnt(4)
    buffer_load_dwordx4 v[176:179], v0, s[44:47], s6 offen offset:0 nt
    s_waitcnt vmcnt(4)
    buffer_load_dwordx4 v[180:183], v0, s[44:47], s6 offen offset:256 nt
    v_and_b32 v20, v4, v157
    v_and_b32 v21, v5, v157
    v_and_b32 v22, v6, v157
    v_and_b32 v23, v7, v157
    s_nop 1
    v_mfma_f32_16x16x32_bf16 v[8:11], v[20:23], v[144:147], v[8:11]
    v_mfma_f32_16x16x32_bf16 v[12:15], v[20:23], v[148:151], v[12:15]
    s_waitcnt vmcnt(4)
    buffer_load_dwordx4 v[184:187], v0, s[44:47], s6 offen offset:2048 nt
    s_waitcnt vmcnt(4)
    buffer_load_dwordx4 v[188:191], v0, s[44:47], s6 offen offset:2304 nt
    v_and_b32 v16, v4, v158
    v_and_b32 v17, v5, v158
    v_and_b32 v18, v6, v158
    v_and_b32 v19, v7, v158
    s_nop 1
    v_mfma_f32_16x16x32_bf16 v[8:11], v[16:19], v[160:163], v[8:11]
    v_mfma_f32_16x16x32_bf16 v[12:15], v[16:19], v[164:167], v[12:15]
    s_xor_b32 s6, s7, 0xc01000
    s_waitcnt vmcnt(4)
    buffer_load_dwordx4 v[192:195], v0, s[44:47], s6 offen offset:0 nt
    s_waitcnt vmcnt(4)
    buffer_load_dwordx4 v[196:199], v0, s[44:47], s6 offen offset:256 nt
    v_and_b32 v20, v4, v159
    v_and_b32 v21, v5, v159
    v_and_b32 v22, v6, v159
    v_and_b32 v23, v7, v159
    s_nop 1
    v_mfma_f32_16x16x32_bf16 v[8:11], v[20:23], v[168:171], v[8:11]
    v_mfma_f32_16x16x32_bf16 v[12:15], v[20:23], v[172:175], v[12:15]
    s_waitcnt vmcnt(4)
    buffer_load_dwordx4 v[208:211], v0, s[44:47], s6 offen offset:2048 nt
    s_waitcnt vmcnt(4)
    buffer_load_dwordx4 v[212:215], v0, s[44:47], s6 offen offset:2304 nt
    v_and_b32 v16, v4, v216
    v_and_b32 v17, v5, v216
    v_and_b32 v18, v6, v216
    v_and_b32 v19, v7, v216
    s_nop 1
    v_mfma_f32_16x16x32_bf16 v[8:11], v[16:19], v[176:179], v[8:11]
    v_mfma_f32_16x16x32_bf16 v[12:15], v[16:19], v[180:183], v[12:15]
    s_xor_b32 s6, s7, 0x411000
    s_waitcnt vmcnt(4)
    buffer_load_dwordx4 v[224:227], v0, s[44:47], s6 offen offset:0 nt
    s_waitcnt vmcnt(4)
    buffer_load_dwordx4 v[228:231], v0, s[44:47], s6 offen offset:256 nt
    v_and_b32 v20, v4, v217
    v_and_b32 v21, v5, v217
    v_and_b32 v22, v6, v217
    v_and_b32 v23, v7, v217
    s_nop 1
    v_mfma_f32_16x16x32_bf16 v[8:11], v[20:23], v[184:187], v[8:11]
    v_mfma_f32_16x16x32_bf16 v[12:15], v[20:23], v[188:191], v[12:15]
    s_waitcnt vmcnt(4)
    buffer_load_dwordx4 v[232:235], v0, s[44:47], s6 offen offset:2048 nt
    s_waitcnt vmcnt(4)
    buffer_load_dwordx4 v[236:239], v0, s[44:47], s6 offen offset:2304 nt
    v_and_b32 v16, v4, v218
    v_and_b32 v17, v5, v218
    v_and_b32 v18, v6, v218
    v_and_b32 v19, v7, v218
    s_nop 1
    v_mfma_f32_16x16x32_bf16 v[8:11], v[16:19], v[192:195], v[8:11]
    v_mfma_f32_16x16x32_bf16 v[12:15], v[16:19], v[196:199], v[12:15]
    s_xor_b32 s6, s7, 0xc11000
    s_waitcnt vmcnt(4)
    buffer_load_dwordx4 v[248:251], v0, s[44:47], s6 offen offset:0 nt
    s_waitcnt vmcnt(4)
    buffer_load_dwordx4 v[252:255], v0, s[44:47], s6 offen offset:256 nt
    v_and_b32 v20, v4, v219
    v_and_b32 v21, v5, v219
    v_and_b32 v22, v6, v219
    v_and_b32 v23, v7, v219
    s_nop 1
    v_mfma_f32_16x16x32_bf16 v[8:11], v[20:23], v[208:211], v[8:11]
    v_mfma_f32_16x16x32_bf16 v[12:15], v[20:23], v[212:215], v[12:15]
    s_waitcnt vmcnt(4)
    buffer_load_dwordx4 v[32:35], v0, s[44:47], s6 offen offset:2048 nt
    s_waitcnt vmcnt(4)
    buffer_load_dwordx4 v[36:39], v0, s[44:47], s6 offen offset:2304 nt
    v_and_b32 v16, v4, v220
    v_and_b32 v17, v5, v220
    v_and_b32 v18, v6, v220
    v_and_b32 v19, v7, v220
    s_nop 1
    v_mfma_f32_16x16x32_bf16 v[8:11], v[16:19], v[224:227], v[8:11]
    v_mfma_f32_16x16x32_bf16 v[12:15], v[16:19], v[228:231], v[12:15]
    s_xor_b32 s6, s7, 0x40000
    s_waitcnt vmcnt(4)
    buffer_load_dwordx4 v[40:43], v0, s[44:47], s6 offen offset:0 nt
    s_waitcnt vmcnt(4)
    buffer_load_dwordx4 v[44:47], v0, s[44:47], s6 offen offset:256 nt
    v_and_b32 v20, v4, v221
    v_and_b32 v21, v5, v221
    v_and_b32 v22, v6, v221
    v_and_b32 v23, v7, v221
    s_nop 1
    v_mfma_f32_16x16x32_bf16 v[8:11], v[20:23], v[232:235], v[8:11]
    v_mfma_f32_16x16x32_bf16 v[12:15], v[20:23], v[236:239], v[12:15]
    s_waitcnt vmcnt(4)
    buffer_load_dwordx4 v[64:67], v0, s[44:47], s6 offen offset:2048 nt
    s_waitcnt vmcnt(4)
    buffer_load_dwordx4 v[68:71], v0, s[44:47], s6 offen offset:2304 nt
    v_and_b32 v16, v4, v222
    v_and_b32 v17, v5, v222
    v_and_b32 v18, v6, v222
    v_and_b32 v19, v7, v222
    s_nop 1
    v_mfma_f32_16x16x32_bf16 v[8:11], v[16:19], v[248:251], v[8:11]
    v_mfma_f32_16x16x32_bf16 v[12:15], v[16:19], v[252:255], v[12:15]
    s_xor_b32 s6, s7, 0x840000
    s_waitcnt vmcnt(4)
    buffer_load_dwordx4 v[72:75], v0, s[44:47], s6 offen offset:0 nt
    s_waitcnt vmcnt(4)
    buffer_load_dwordx4 v[76:79], v0, s[44:47], s6 offen offset:256 nt
    v_and_b32 v20, v4, v223
    v_and_b32 v21, v5, v223
    v_and_b32 v22, v6, v223
    v_and_b32 v23, v7, v223
    s_nop 1
    v_mfma_f32_16x16x32_bf16 v[8:11], v[20:23], v[32:35], v[8:11]
    v_mfma_f32_16x16x32_bf16 v[12:15], v[20:23], v[36:39], v[12:15]
    s_waitcnt vmcnt(4)
    buffer_load_dwordx4 v[80:83], v0, s[44:47], s6 offen offset:2048 nt
    s_waitcnt vmcnt(4)
    buffer_load_dwordx4 v[84:87], v0, s[44:47], s6 offen offset:2304 nt
    v_and_b32 v16, v4, v56
    v_and_b32 v17, v5, v56
    v_and_b32 v18, v6, v56
    v_and_b32 v19, v7, v56
    s_nop 1
    v_mfma_f32_16x16x32_bf16 v[8:11], v[16:19], v[40:43], v[8:11]
    v_mfma_f32_16x16x32_bf16 v[12:15], v[16:19], v[44:47], v[12:15]
    s_xor_b32 s6, s7, 0x50000
    s_waitcnt vmcnt(4)
    buffer_load_dwordx4 v[96:99], v0, s[44:47], s6 offen offset:0 nt
    s_waitcnt vmcnt(4)
    buffer_load_dwordx4 v[100:103], v0, s[44:47], s6 offen offset:256 nt
    v_and_b32 v20, v4, v57
    v_and_b32 v21, v5, v57
    v_and_b32 v22, v6, v57
    v_and_b32 v23, v7, v57
    s_nop 1
    v_mfma_f32_16x16x32_bf16 v[8:11], v[20:23], v[64:67], v[8:11]
    v_mfma_f32_16x16x32_bf16 v[12:15], v[20:23], v[68:71], v[12:15]
    s_waitcnt vmcnt(4)
    buffer_load_dwordx4 v[104:107], v0, s[44:47], s6 offen offset:2048 nt
    s_waitcnt vmcnt(4)
    buffer_load_dwordx4 v[108:111], v0, s[44:47], s6 offen offset:2304 nt
    v_and_b32 v16, v4, v58
    v_and_b32 v17, v5, v58
    v_and_b32 v18, v6, v58
    v_and_b32 v19, v7, v58
    s_nop 1
    v_mfma_f32_16x16x32_bf16 v[8:11], v[16:19], v[72:75], v[8:11]
    v_mfma_f32_16x16x32_bf16 v[12:15], v[16:19], v[76:79], v[12:15]
    s_xor_b32 s6, s7, 0x850000
    s_waitcnt vmcnt(4)
    buffer_load_dwordx4 v[112:115], v0, s[44:47], s6 offen offset:0 nt
    s_waitcnt vmcnt(4)
    buffer_load_dwordx4 v[116:119], v0, s[44:47], s6 offen offset:256 nt
    v_and_b32 v20, v4, v59
    v_and_b32 v21, v5, v59
    v_and_b32 v22, v6, v59
    v_and_b32 v23, v7, v59
    s_nop 1
    v_mfma_f32_16x16x32_bf16 v[8:11], v[20:23], v[80:83], v[8:11]
    v_mfma_f32_16x16x32_bf16 v[12:15], v[20:23], v[84:87], v[12:15]
    s_waitcnt vmcnt(4)
    buffer_load_dwordx4 v[120:123], v0, s[44:47], s6 offen offset:2048 nt
    s_waitcnt vmcnt(4)
    buffer_load_dwordx4 v[124:127], v0, s[44:47], s6 offen offset:2304 nt
    v_and_b32 v16, v4, v60
    v_and_b32 v17, v5, v60
    v_and_b32 v18, v6, v60
    v_and_b32 v19, v7, v60
    s_nop 1
    v_mfma_f32_16x16x32_bf16 v[8:11], v[16:19], v[96:99], v[8:11]
    v_mfma_f32_16x16x32_bf16 v[12:15], v[16:19], v[100:103], v[12:15]
    s_mov_b64 exec, 1
    ds_add_u32 v243, v244 offset:8
    s_mov_b64 exec, -1
    s_xor_b32 s6, s7, 0x41000
    s_waitcnt vmcnt(4)
    buffer_load_dwordx4 v[136:139], v0, s[44:47], s6 offen offset:0 nt
    s_waitcnt vmcnt(4)
    buffer_load_dwordx4 v[140:143], v0, s[44:47], s6 offen offset:256 nt
    v_and_b32 v20, v4, v61
    v_and_b32 v21, v5, v61
    v_and_b32 v22, v6, v61
    v_and_b32 v23, v7, v61
    s_nop 1
    v_mfma_f32_16x16x32_bf16 v[8:11], v[20:23], v[104:107], v[8:11]
    v_mfma_f32_16x16x32_bf16 v[12:15], v[20:23], v[108:111], v[12:15]
    s_waitcnt vmcnt(4)
    buffer_load_dwordx4 v[144:147], v0, s[44:47], s6 offen offset:2048 nt
    s_waitcnt vmcnt(4)
    buffer_load_dwordx4 v[148:151], v0, s[44:47], s6 offen offset:2304 nt
    v_and_b32 v16, v4, v62
    v_and_b32 v17, v5, v62
    v_and_b32 v18, v6, v62
    v_and_b32 v19, v7, v62
    s_nop 1
    v_mfma_f32_16x16x32_bf16 v[8:11], v[16:19], v[112:115], v[8:11]
    v_mfma_f32_16x16x32_bf16 v[12:15], v[16:19], v[116:119], v[12:15]
    s_xor_b32 s6, s7, 0x841000
    s_waitcnt vmcnt(4)
    buffer_load_dwordx4 v[160:163], v0, s[44:47], s6 offen offset:0 nt
    s_waitcnt vmcnt(4)
    buffer_load_dwordx4 v[164:167], v0, s[44:47], s6 offen offset:256 nt
    v_and_b32 v20, v4, v63
    v_and_b32 v21, v5, v63
    v_and_b32 v22, v6, v63
    v_and_b32 v23, v7, v63
    s_nop 1
    v_mfma_f32_16x16x32_bf16 v[8:11], v[20:23], v[120:123], v[8:11]
    v_mfma_f32_16x16x32_bf16 v[12:15], v[20:23], v[124:127], v[12:15]
    s_waitcnt vmcnt(4)
    buffer_load_dwordx4 v[168:171], v0, s[44:47], s6 offen offset:2048 nt
    s_waitcnt vmcnt(4)
    buffer_load_dwordx4 v[172:175], v0, s[44:47], s6 offen offset:2304 nt
    v_and_b32 v16, v4, v128
    v_and_b32 v17, v5, v128
    v_and_b32 v18, v6, v128
    v_and_b32 v19, v7, v128
    s_nop 1
    v_mfma_f32_16x16x32_bf16 v[8:11], v[16:19], v[136:139], v[8:11]
    v_mfma_f32_16x16x32_bf16 v[12:15], v[16:19], v[140:143], v[12:15]
    s_xor_b32 s6, s7, 0x51000
    s_waitcnt vmcnt(4)
    buffer_load_dwordx4 v[176:179], v0, s[44:47], s6 offen offset:0 nt
    s_waitcnt vmcnt(4)
    buffer_load_dwordx4 v[180:183], v0, s[44:47], s6 offen offset:256 nt
    v_and_b32 v20, v4, v129
    v_and_b32 v21, v5, v129
    v_and_b32 v22, v6, v129
    v_and_b32 v23, v7, v129
    s_nop 1
    v_mfma_f32_16x16x32_bf16 v[8:11], v[20:23], v[144:147], v[8:11]
    v_mfma_f32_16x16x32_bf16 v[12:15], v[20:23], v[148:151], v[12:15]
    s_waitcnt vmcnt(4)
    buffer_load_dwordx4 v[184:187], v0, s[44:47], s6 offen offset:2048 nt
    s_waitcnt vmcnt(4)
    buffer_load_dwordx4 v[188:191], v0, s[44:47], s6 offen offset:2304 nt
    v_and_b32 v16, v4, v130
    v_and_b32 v17, v5, v130
    v_and_b32 v18, v6, v130
    v_and_b32 v19, v7, v130
    s_nop 1
    v_mfma_f32_16x16x32_bf16 v[8:11], v[16:19], v[160:163], v[8:11]
    v_mfma_f32_16x16x32_bf16 v[12:15], v[16:19], v[164:167], v[12:15]
    s_xor_b32 s6, s7, 0x851000
    s_waitcnt vmcnt(4)
    buffer_load_dwordx4 v[192:195], v0, s[44:47], s6 offen offset:0 nt
    s_waitcnt vmcnt(4)
    buffer_load_dwordx4 v[196:199], v0, s[44:47], s6 offen offset:256 nt
    v_and_b32 v20, v4, v131
    v_and_b32 v21, v5, v131
    v_and_b32 v22, v6, v131
    v_and_b32 v23, v7, v131
    s_nop 1
    v_mfma_f32_16x16x32_bf16 v[8:11], v[20:23], v[168:171], v[8:11]
    v_mfma_f32_16x16x32_bf16 v[12:15], v[20:23], v[172:175], v[12:15]
    s_waitcnt vmcnt(4)
    buffer_load_dwordx4 v[208:211], v0, s[44:47], s6 offen offset:2048 nt
    s_waitcnt vmcnt(4)
    buffer_load_dwordx4 v[212:215], v0, s[44:47], s6 offen offset:2304 nt
    v_and_b32 v16, v4, v132
    v_and_b32 v17, v5, v132
    v_and_b32 v18, v6, v132
    v_and_b32 v19, v7, v132
    s_nop 1
    v_mfma_f32_16x16x32_bf16 v[8:11], v[16:19], v[176:179], v[8:11]
    v_mfma_f32_16x16x32_bf16 v[12:15], v[16:19], v[180:183], v[12:15]
    s_xor_b32 s6, s7, 0x440000
    buffer_load_dwordx4 v[224:227], v0, s[44:47], s6 offen offset:0 nt
    buffer_load_dwordx4 v[228:231], v0, s[44:47], s6 offen offset:256 nt
    buffer_load_dwordx4 v[232:235], v0, s[44:47], s6 offen offset:2048 nt
    s_waitcnt vmcnt(7)
    buffer_load_dwordx4 v[236:239], v0, s[44:47], s6 offen offset:2304 nt
    v_and_b32 v20, v4, v133
    v_and_b32 v21, v5, v133
    v_and_b32 v22, v6, v133
    v_and_b32 v23, v7, v133
    s_nop 1
    v_mfma_f32_16x16x32_bf16 v[8:11], v[20:23], v[184:187], v[8:11]
    v_mfma_f32_16x16x32_bf16 v[12:15], v[20:23], v[188:191], v[12:15]
    s_xor_b32 s6, s7, 0xc40000
    s_waitcnt vmcnt(7)
    buffer_load_dwordx4 v[248:251], v0, s[44:47], s6 offen offset:0 nt
    s_waitcnt vmcnt(7)
    buffer_load_dwordx4 v[252:255], v0, s[44:47], s6 offen offset:256 nt
    v_and_b32 v16, v4, v134
    v_and_b32 v17, v5, v134
    v_and_b32 v18, v6, v134
    v_and_b32 v19, v7, v134
    s_nop 1
    v_mfma_f32_16x16x32_bf16 v[8:11], v[16:19], v[192:195], v[8:11]
    v_mfma_f32_16x16x32_bf16 v[12:15], v[16:19], v[196:199], v[12:15]
    s_waitcnt vmcnt(7)
    buffer_load_dwordx4 v[32:35], v0, s[44:47], s6 offen offset:2048 nt
    s_waitcnt vmcnt(7)
    buffer_load_dwordx4 v[36:39], v0, s[44:47], s6 offen offset:2304 nt
    v_and_b32 v20, v4, v135
    v_and_b32 v21, v5, v135
    v_and_b32 v22, v6, v135
    v_and_b32 v23, v7, v135
    s_nop 1
    v_mfma_f32_16x16x32_bf16 v[8:11], v[20:23], v[208:211], v[8:11]
    v_mfma_f32_16x16x32_bf16 v[12:15], v[20:23], v[212:215], v[12:15]
    s_xor_b32 s6, s7, 0x450000
    s_waitcnt vmcnt(7)
    buffer_load_dwordx4 v[40:43], v0, s[44:47], s6 offen offset:0 nt
    s_waitcnt vmcnt(7)
    buffer_load_dwordx4 v[44:47], v0, s[44:47], s6 offen offset:256 nt
    v_and_b32 v16, v4, v200
    v_and_b32 v17, v5, v200
    v_and_b32 v18, v6, v200
    v_and_b32 v19, v7, v200
    s_nop 1
    v_mfma_f32_16x16x32_bf16 v[8:11], v[16:19], v[224:227], v[8:11]
    v_mfma_f32_16x16x32_bf16 v[12:15], v[16:19], v[228:231], v[12:15]
    s_waitcnt vmcnt(7)
    buffer_load_dwordx4 v[64:67], v0, s[44:47], s6 offen offset:2048 nt
    s_waitcnt vmcnt(7)
    buffer_load_dwordx4 v[68:71], v0, s[44:47], s6 offen offset:2304 nt
    v_and_b32 v20, v4, v201
    v_and_b32 v21, v5, v201
    v_and_b32 v22, v6, v201
    v_and_b32 v23, v7, v201
    s_nop 1
    v_mfma_f32_16x16x32_bf16 v[8:11], v[20:23], v[232:235], v[8:11]
    v_mfma_f32_16x16x32_bf16 v[12:15], v[20:23], v[236:239], v[12:15]
    s_xor_b32 s6, s7, 0xc50000
    s_waitcnt vmcnt(7)
    buffer_load_dwordx4 v[72:75], v0, s[44:47], s6 offen offset:0 nt
    s_waitcnt vmcnt(7)
    buffer_load_dwordx4 v[76:79], v0, s[44:47], s6 offen offset:256 nt
    v_and_b32 v16, v4, v202
    v_and_b32 v17, v5, v202
    v_and_b32 v18, v6, v202
    v_and_b32 v19, v7, v202
    s_nop 1
    v_mfma_f32_16x16x32_bf16 v[8:11], v[16:19], v[248:251], v[8:11]
    v_mfma_f32_16x16x32_bf16 v[12:15], v[16:19], v[252:255], v[12:15]
    s_waitcnt vmcnt(7)
    buffer_load_dwordx4 v[80:83], v0, s[44:47], s6 offen offset:2048 nt
    s_waitcnt vmcnt(7)
    buffer_load_dwordx4 v[84:87], v0, s[44:47], s6 offen offset:2304 nt
    v_and_b32 v20, v4, v203
    v_and_b32 v21, v5, v203
    v_and_b32 v22, v6, v203
    v_and_b32 v23, v7, v203
    s_nop 1
    v_mfma_f32_16x16x32_bf16 v[8:11], v[20:23], v[32:35], v[8:11]
    v_mfma_f32_16x16x32_bf16 v[12:15], v[20:23], v[36:39], v[12:15]
    s_xor_b32 s6, s7, 0x441000
    s_waitcnt vmcnt(7)
    buffer_load_dwordx4 v[96:99], v0, s[44:47], s6 offen offset:0 nt
    s_waitcnt vmcnt(7)
    buffer_load_dwordx4 v[100:103], v0, s[44:47], s6 offen offset:256 nt
    v_and_b32 v16, v4, v204
    v_and_b32 v17, v5, v204
    v_and_b32 v18, v6, v204
    v_and_b32 v19, v7, v204
    s_nop 1
    v_mfma_f32_16x16x32_bf16 v[8:11], v[16:19], v[40:43], v[8:11]
    v_mfma_f32_16x16x32_bf16 v[12:15], v[16:19], v[44:47], v[12:15]
    s_waitcnt vmcnt(7)
    buffer_load_dwordx4 v[104:107], v0, s[44:47], s6 offen offset:2048 nt
    s_waitcnt vmcnt(7)
    buffer_load_dwordx4 v[108:111], v0, s[44:47], s6 offen offset:2304 nt
    v_and_b32 v20, v4, v205
    v_and_b32 v21, v5, v205
    v_and_b32 v22, v6, v205
    v_and_b32 v23, v7, v205
    s_nop 1
    v_mfma_f32_16x16x32_bf16 v[8:11], v[20:23], v[64:67], v[8:11]
    v_mfma_f32_16x16x32_bf16 v[12:15], v[20:23], v[68:71], v[12:15]
    s_xor_b32 s6, s7, 0xc41000
    s_waitcnt vmcnt(7)
    buffer_load_dwordx4 v[112:115], v0, s[44:47], s6 offen offset:0 nt
    s_waitcnt vmcnt(7)
    buffer_load_dwordx4 v[116:119], v0, s[44:47], s6 offen offset:256 nt
    v_and_b32 v16, v4, v206
    v_and_b32 v17, v5, v206
    v_and_b32 v18, v6, v206
    v_and_b32 v19, v7, v206
    s_nop 1
    v_mfma_f32_16x16x32_bf16 v[8:11], v[16:19], v[72:75], v[8:11]
    v_mfma_f32_16x16x32_bf16 v[12:15], v[16:19], v[76:79], v[12:15]
    s_waitcnt vmcnt(7)
    buffer_load_dwordx4 v[120:123], v0, s[44:47], s6 offen offset:2048 nt
    s_waitcnt vmcnt(7)
    buffer_load_dwordx4 v[124:127], v0, s[44:47], s6 offen offset:2304 nt
    v_and_b32 v20, v4, v207
    v_and_b32 v21, v5, v207
    v_and_b32 v22, v6, v207
    v_and_b32 v23, v7, v207
    s_nop 1
    v_mfma_f32_16x16x32_bf16 v[8:11], v[20:23], v[80:83], v[8:11]
    v_mfma_f32_16x16x32_bf16 v[12:15], v[20:23], v[84:87], v[12:15]
    s_xor_b32 s6, s7, 0x451000
    s_waitcnt vmcnt(7)
    buffer_load_dwordx4 v[136:139], v0, s[44:47], s6 offen offset:0 nt
    s_waitcnt vmcnt(7)
    buffer_load_dwordx4 v[140:143], v0, s[44:47], s6 offen offset:256 nt
    v_and_b32 v16, v4, v48
    v_and_b32 v17, v5, v48
    v_and_b32 v18, v6, v48
    v_and_b32 v19, v7, v48
    s_nop 1
    v_mfma_f32_16x16x32_bf16 v[8:11], v[16:19], v[96:99], v[8:11]
    v_mfma_f32_16x16x32_bf16 v[12:15], v[16:19], v[100:103], v[12:15]
    s_waitcnt vmcnt(7)
    buffer_load_dwordx4 v[144:147], v0, s[44:47], s6 offen offset:2048 nt
    s_waitcnt vmcnt(7)
    buffer_load_dwordx4 v[148:151], v0, s[44:47], s6 offen offset:2304 nt
    v_and_b32 v20, v4, v49
    v_and_b32 v21, v5, v49
    v_and_b32 v22, v6, v49
    v_and_b32 v23, v7, v49
    s_nop 1
    v_mfma_f32_16x16x32_bf16 v[8:11], v[20:23], v[104:107], v[8:11]
    v_mfma_f32_16x16x32_bf16 v[12:15], v[20:23], v[108:111], v[12:15]
    s_xor_b32 s6, s7, 0xc51000
    s_waitcnt vmcnt(7)
    buffer_load_dwordx4 v[160:163], v0, s[44:47], s6 offen offset:0 nt
    s_waitcnt vmcnt(7)
    buffer_load_dwordx4 v[164:167], v0, s[44:47], s6 offen offset:256 nt
    v_and_b32 v16, v4, v50
    v_and_b32 v17, v5, v50
    v_and_b32 v18, v6, v50
    v_and_b32 v19, v7, v50
    s_nop 1
    v_mfma_f32_16x16x32_bf16 v[8:11], v[16:19], v[112:115], v[8:11]
    v_mfma_f32_16x16x32_bf16 v[12:15], v[16:19], v[116:119], v[12:15]
    s_waitcnt vmcnt(7)
    buffer_load_dwordx4 v[168:171], v0, s[44:47], s6 offen offset:2048 nt
    s_waitcnt vmcnt(7)
    buffer_load_dwordx4 v[172:175], v0, s[44:47], s6 offen offset:2304 nt
    v_and_b32 v20, v4, v51
    v_and_b32 v21, v5, v51
    v_and_b32 v22, v6, v51
    v_and_b32 v23, v7, v51
    s_nop 1
    v_mfma_f32_16x16x32_bf16 v[8:11], v[20:23], v[120:123], v[8:11]
    v_mfma_f32_16x16x32_bf16 v[12:15], v[20:23], v[124:127], v[12:15]
    v_and_b32 v176, 15, v3
    v_lshlrev_b32 v176, 5, v176
    v_bfe_u32 v177, v3, 4, 1
    v_lshl_add_u32 v176, v177, 4, v176
    v_lshrrev_b32 v177, 5, v3
    v_lshl_add_u32 v176, v177, 10, v176
    s_lshl_b32 s49, s3, 11
    v_add_u32 v176, s49, v176
    v_and_b32 v16, v4, v52
    v_and_b32 v17, v5, v52
    v_and_b32 v18, v6, v52
    v_and_b32 v19, v7, v52
    s_waitcnt vmcnt(6)
    s_nop 0
    v_mfma_f32_16x16x32_bf16 v[8:11], v[16:19], v[136:139], v[8:11]
    v_mfma_f32_16x16x32_bf16 v[12:15], v[16:19], v[140:143], v[12:15]
    v_and_b32 v20, v4, v53
    v_and_b32 v21, v5, v53
    v_and_b32 v22, v6, v53
    v_and_b32 v23, v7, v53
    s_waitcnt vmcnt(4)
    s_nop 0
    v_mfma_f32_16x16x32_bf16 v[8:11], v[20:23], v[144:147], v[8:11]
    v_mfma_f32_16x16x32_bf16 v[12:15], v[20:23], v[148:151], v[12:15]
    v_and_b32 v16, v4, v54
    v_and_b32 v17, v5, v54
    v_and_b32 v18, v6, v54
    v_and_b32 v19, v7, v54
    s_waitcnt vmcnt(2)
    s_nop 0
    v_mfma_f32_16x16x32_bf16 v[8:11], v[16:19], v[160:163], v[8:11]
    v_mfma_f32_16x16x32_bf16 v[12:15], v[16:19], v[164:167], v[12:15]
    v_and_b32 v20, v4, v55
    v_and_b32 v21, v5, v55
    v_and_b32 v22, v6, v55
    v_and_b32 v23, v7, v55
    s_waitcnt vmcnt(0)
    s_nop 0
    v_mfma_f32_16x16x32_bf16 v[8:11], v[20:23], v[168:171], v[8:11]
    v_mfma_f32_16x16x32_bf16 v[12:15], v[20:23], v[172:175], v[12:15]
    s_nop 6
    ds_write_b128 v176, v[8:11] offset:6144
    ds_write_b128 v176, v[12:15] offset:6656
    s_waitcnt lgkmcnt(0)
    s_barrier
    s_endpgm
L_HE:
    s_waitcnt vmcnt(0)
    v_readfirstlane_b32 s61, v1
    s_nop 0
    s_add_u32 s61, s61, 1
    s_and_b32 s14, s61, 0xffff
    s_xor_b32 s15, s14, 0x8000
    s_and_b32 s6, s61, 0xff
    s_xor_b32 s7, s6, 0x80
    s_branch L_Q
L_P1a:
    s_lshl_b32 s52, s13, 7
    s_waitcnt vmcnt(0)
    s_mov_b64 s[40:41], s[36:37]
    s_mov_b32 s42, 2408448
    s_mov_b32 s51, 5376
    s_mov_b32 s57, 3
    s_mov_b32 s58, 14
    v_lshrrev_b32 v6, s57, v3
    v_mul_lo_u32 v17, v6, s51
    v_lshlrev_b32 v7, s57, v6
    v_sub_u32 v7, v3, v7
    s_cmp_eq_u32 s57, 3
    s_cselect_b32 s59, 2, 0
    v_and_b32 v6, s59, v6
    v_xor_b32 v7, v7, v6
    v_lshl_add_u32 v17, v7, 4, v17
    s_lshl_b32 s59, s59, 5
    s_sub_u32 s53, 6, s57
    s_lshl_b32 s53, s51, s53
    s_mul_i32 s54, s12, s58
    s_mul_i32 s55, s54, s53
    s_add_u32 s52, s52, s55
    s_lshl_b32 s54, s54, 10
    s_add_u32 m0, s54, 30720
    s_mov_b32 s55, s58
L_dma_4:
    s_cmp_eq_u32 s69, 0
    s_cbranch_scc1 L_dma_4_np
    s_waitcnt vmcnt(1)
L_dma_4_np:
    buffer_load_dwordx4 v17, s[40:43], s52 offen  lds
    s_add_u32 s52, s52, s53
    s_add_u32 m0, m0, 1024
    v_xor_b32 v17, s59, v17
    s_sub_u32 s55, s55, 1
    s_cmp_lg_u32 s55, 0
    s_cbranch_scc1 L_dma_4
    s_cmp_eq_u32 s69, 0
    s_cbranch_scc0 L_p1b_5
    s_barrier
L_p1b_5:
    v_readfirstlane_b32 s61, v1
    s_nop 0
    s_add_u32 s61, s61, 1
    s_and_b32 s14, s61, 0xffff
    s_xor_b32 s15, s14, 0x8000
    s_and_b32 s6, s61, 0xff
    s_xor_b32 s7, s6, 0x80
    v_lshlrev_b32 v24, 16, v20
    v_and_b32 v25, 0xffff0000, v20
    v_lshlrev_b32 v26, 16, v21
    v_and_b32 v27, 0xffff0000, v21
    v_lshlrev_b32 v28, 16, v22
    v_and_b32 v29, 0xffff0000, v22
    v_lshlrev_b32 v30, 16, v23
    v_and_b32 v31, 0xffff0000, v23
    s_mov_b32 s53, 0xbfb8aa3b
    v_mul_f32 v32, s53, v24
    v_mul_f32 v33, s53, v25
    v_mul_f32 v34, s53, v26
    v_mul_f32 v35, s53, v27
    v_mul_f32 v36, s53, v28
    v_mul_f32 v37, s53, v29
    v_mul_f32 v38, s53, v30
    v_mul_f32 v39, s53, v31
    v_exp_f32 v32, v32
    v_exp_f32 v33, v33
    v_exp_f32 v34, v34
    v_exp_f32 v35, v35
    v_exp_f32 v36, v36
    v_exp_f32 v37, v37
    v_exp_f32 v38, v38
    v_exp_f32 v39, v39
    v_add_f32 v32, 1.0, v32
    v_add_f32 v33, 1.0, v33
    v_add_f32 v34, 1.0, v34
    v_add_f32 v35, 1.0, v35
    v_add_f32 v36, 1.0, v36
    v_add_f32 v37, 1.0, v37
    v_add_f32 v38, 1.0, v38
    v_add_f32 v39, 1.0, v39
    v_rcp_f32 v32, v32
    v_rcp_f32 v33, v33
    v_rcp_f32 v34, v34
    v_rcp_f32 v35, v35
    v_rcp_f32 v36, v36
    v_rcp_f32 v37, v37
    v_rcp_f32 v38, v38
    v_rcp_f32 v39, v39
    v_mul_f32 v32, v32, v24
    v_mul_f32 v33, v33, v25
    v_mul_f32 v34, v34, v26
    v_mul_f32 v35, v35, v27
    v_mul_f32 v36, v36, v28
    v_mul_f32 v37, v37, v29
    v_mul_f32 v38, v38, v30
    v_mul_f32 v39, v39, v31
    v_cvt_pk_bf16_f32 v20, v32, v33
    v_cvt_pk_bf16_f32 v21, v34, v35
    v_cvt_pk_bf16_f32 v22, v36, v37
    v_cvt_pk_bf16_f32 v23, v38, v39
    s_lshl_b32 s53, s12, 10
    v_lshl_add_u32 v10, v3, 4, s53
    ds_write_b128 v10, v[20:23] offset:2048
L_P1:
    s_lshl_b32 s56, s13, 8
    s_add_u32 s56, s56, 0x1000
    s_lshl_b32 s59, s12, 10
    s_waitcnt vmcnt(0)
    s_mov_b64 exec, 1
    v_mov_b32 v4, 0
    v_mov_b32 v5, 1
    ds_add_u32 v4, v5 offset:0
L_hb_6:
    ds_read_b32 v6, v4 offset:0
    s_waitcnt lgkmcnt(0)
    v_cmp_le_u32 vcc, s68, v6
    s_cbranch_vccnz L_hb_6_ok
    s_add_u32 s60, s60, 1
    s_cmp_lt_u32 s60, 0x200000
    s_cbranch_scc1 L_hb_6
    s_branch L_exit
L_hb_6_ok:
    s_mov_b64 exec, -1
    s_add_u32 s68, s68, 4
    v_lshrrev_b32 v4, 4, v3
    v_bfe_u32 v5, v3, 2, 2
    v_lshl_add_u32 v6, v4, 3, v5
    v_lshlrev_b32 v6, 7, v6
    v_and_b32 v4, 1, v4
    v_lshlrev_b32 v4, 2, v4
    v_and_b32 v5, 2, v5
    v_or_b32 v4, v4, v5
    v_bfe_u32 v5, v3, 1, 1
    s_lshl_b32 s53, s12, 1
    v_add_u32 v5, s53, v5
    v_xor_b32 v4, v4, v5
    v_lshl_add_u32 v6, v4, 4, v6
    v_and_b32 v5, 1, v3
    v_lshl_add_u32 v6, v5, 3, v6
    v_add_u32 v7, 30720, v6
    ds_read_b64_tr_b16 v[64:65], v7 offset:0
    ds_read_b64_tr_b16 v[66:67], v7 offset:512
    ds_read_b64_tr_b16 v[68:69], v7 offset:4096
    ds_read_b64_tr_b16 v[70:71], v7 offset:4608
    ds_read_b64_tr_b16 v[72:73], v7 offset:8192
    ds_read_b64_tr_b16 v[74:75], v7 offset:8704
    ds_read_b64_tr_b16 v[76:77], v7 offset:12288
    ds_read_b64_tr_b16 v[78:79], v7 offset:12800
    ds_read_b64_tr_b16 v[80:81], v7 offset:16384
    ds_read_b64_tr_b16 v[82:83], v7 offset:16896
    ds_read_b64_tr_b16 v[84:85], v7 offset:20480
    ds_read_b64_tr_b16 v[86:87], v7 offset:20992
    ds_read_b64_tr_b16 v[88:89], v7 offset:24576
    ds_read_b64_tr_b16 v[90:91], v7 offset:25088
    ds_read_b64_tr_b16 v[92:93], v7 offset:28672
    ds_read_b64_tr_b16 v[94:95], v7 offset:29184
    ds_read_b64_tr_b16 v[96:97], v7 offset:32768
    ds_read_b64_tr_b16 v[98:99], v7 offset:33280
    ds_read_b64_tr_b16 v[100:101], v7 offset:36864
    ds_read_b64_tr_b16 v[102:103], v7 offset:37376
    ds_read_b64_tr_b16 v[104:105], v7 offset:40960
    ds_read_b64_tr_b16 v[106:107], v7 offset:41472
    ds_read_b64_tr_b16 v[108:109], v7 offset:45056
    ds_read_b64_tr_b16 v[110:111], v7 offset:45568
    ds_read_b64_tr_b16 v[112:113], v7 offset:49152
    ds_read_b64_tr_b16 v[114:115], v7 offset:49664
    ds_read_b64_tr_b16 v[116:117], v7 offset:53248
    ds_read_b64_tr_b16 v[118:119], v7 offset:53760
    s_branch L_PG
L_P2:
    v_min_u32 v9, 27, v3
    s_mul_i32 s53, s12, 224
    v_lshl_add_u32 v9, v9, 3, s53
    buffer_load_dwordx2 v[48:49], v9, s[44:47], 0 offen
    s_sub_u32 s13, s5, 24
    s_lshl_b32 s53, s4, 3
    s_add_u32 s13, s13, s53
    v_cmp_gt_u32 s[62:63], 56, v3
    s_lshl_b32 s52, s13, 7
    s_waitcnt vmcnt(0)
    s_mov_b64 s[40:41], s[22:23]
    s_mov_b32 s42, 3670016
    s_mov_b32 s51, 8192
    s_mov_b32 s57, 3
    s_mov_b32 s58, 14
    v_lshrrev_b32 v6, s57, v3
    v_mul_lo_u32 v17, v6, s51
    v_lshlrev_b32 v7, s57, v6
    v_sub_u32 v7, v3, v7
    s_cmp_eq_u32 s57, 3
    s_cselect_b32 s59, 2, 0
    v_and_b32 v6, s59, v6
    v_xor_b32 v7, v7, v6
    v_lshl_add_u32 v17, v7, 4, v17
    s_lshl_b32 s59, s59, 5
    s_sub_u32 s53, 6, s57
    s_lshl_b32 s53, s51, s53
    s_mul_i32 s54, s12, s58
    s_mul_i32 s55, s54, s53
    s_add_u32 s52, s52, s55
    s_lshl_b32 s54, s54, 10
    s_add_u32 m0, s54, 30720
    s_mov_b32 s55, s58
L_dma_7:
    buffer_load_dwordx4 v17, s[40:43], s52 offen  lds
    s_add_u32 s52, s52, s53
    s_add_u32 m0, m0, 1024
    v_xor_b32 v17, s59, v17
    s_sub_u32 s55, s55, 1
    s_cmp_lg_u32 s55, 0
    s_cbranch_scc1 L_dma_7
    v_readfirstlane_b32 s61, v1
    s_nop 0
    s_add_u32 s61, s61, 1
    s_and_b32 s14, s61, 0xffff
    s_xor_b32 s15, s14, 0x8000
    s_and_b32 s6, s61, 0xff
    s_xor_b32 s7, s6, 0x80
    v_lshlrev_b32 v24, 16, v20
    v_and_b32 v25, 0xffff0000, v20
    v_lshlrev_b32 v26, 16, v21
    v_and_b32 v27, 0xffff0000, v21
    v_lshlrev_b32 v28, 16, v22
    v_and_b32 v29, 0xffff0000, v22
    v_lshlrev_b32 v30, 16, v23
    v_and_b32 v31, 0xffff0000, v23
    v_add_f32 v32, v24, v25
    v_add_f32 v32, v32, v26
    v_add_f32 v32, v32, v27
    v_add_f32 v32, v32, v28
    v_add_f32 v32, v32, v29
    v_add_f32 v32, v32, v30
    v_add_f32 v32, v32, v31
    v_cndmask_b32 v32, 0, v32, s[62:63]
    s_nop 1
    v_add_f32_dpp v32, v32, v32 row_ror:8 row_mask:0xf bank_mask:0xf
    s_nop 1
    v_add_f32_dpp v32, v32, v32 row_ror:4 row_mask:0xf bank_mask:0xf
    s_nop 1
    v_add_f32_dpp v32, v32, v32 row_ror:2 row_mask:0xf bank_mask:0xf
    s_nop 1
    v_add_f32_dpp v32, v32, v32 row_ror:1 row_mask:0xf bank_mask:0xf
    v_mov_b32 v33, v32
    s_nop 1
    v_permlane16_swap_b32 v32, v33
    v_add_f32 v32, v32, v33
    v_mov_b32 v33, v32
    s_nop 1
    v_permlane32_swap_b32 v32, v33
    v_add_f32 v32, v32, v33
    v_mul_f32 v32, 0x3b124925, v32
    v_sub_f32 v40, v24, v32
    v_sub_f32 v41, v25, v32
    v_sub_f32 v42, v26, v32
    v_sub_f32 v43, v27, v32
    v_sub_f32 v44, v28, v32
    v_sub_f32 v45, v29, v32
    v_sub_f32 v46, v30, v32
    v_sub_f32 v47, v31, v32
    v_mul_f32 v34, v40, v40
    v_fmac_f32 v34, v41, v41
    v_fmac_f32 v34, v42, v42
    v_fmac_f32 v34, v43, v43
    v_fmac_f32 v34, v44, v44
    v_fmac_f32 v34, v45, v45
    v_fmac_f32 v34, v46, v46
    v_fmac_f32 v34, v47, v47
    v_cndmask_b32 v34, 0, v34, s[62:63]
    s_nop 1
    v_add_f32_dpp v34, v34, v34 row_ror:8 row_mask:0xf bank_mask:0xf
    s_nop 1
    v_add_f32_dpp v34, v34, v34 row_ror:4 row_mask:0xf bank_mask:0xf
    s_nop 1
    v_add_f32_dpp v34, v34, v34 row_ror:2 row_mask:0xf bank_mask:0xf
    s_nop 1
    v_add_f32_dpp v34, v34, v34 row_ror:1 row_mask:0xf bank_mask:0xf
    v_mov_b32 v33, v34
    s_nop 1
    v_permlane16_swap_b32 v34, v33
    v_add_f32 v34, v34, v33
    v_mov_b32 v33, v34
    s_nop 1
    v_permlane32_swap_b32 v34, v33
    v_add_f32 v34, v34, v33
    v_mul_f32 v34, 0x3b124925, v34
    v_cvt_pk_bf16_f32 v34, 0, v34
    v_add_f32 v34, 0x3727c5ac, v34
    v_cvt_pk_bf16_f32 v34, 0, v34
    v_sqrt_f32 v34, v34
    v_cvt_pk_bf16_f32 v32, 0, v32
    v_cvt_pk_bf16_f32 v34, 0, v34
    v_rcp_f32 v34, v34
    s_lshl_b32 s56, s13, 8
    s_add_u32 s56, s56, 0x4000
    s_mov_b32 s59, 0
    s_waitcnt vmcnt(0)
    s_mov_b64 exec, 1
    v_mov_b32 v4, 0
    v_mov_b32 v5, 1
    ds_add_u32 v4, v5 offset:0
L_hb_8:
    ds_read_b32 v6, v4 offset:0
    s_waitcnt lgkmcnt(0)
    v_cmp_le_u32 vcc, s68, v6
    s_cbranch_vccnz L_hb_8_ok
    s_add_u32 s60, s60, 1
    s_cmp_lt_u32 s60, 0x200000
    s_cbranch_scc1 L_hb_8
    s_branch L_exit
L_hb_8_ok:
    s_mov_b64 exec, -1
    s_add_u32 s68, s68, 4
    v_lshrrev_b32 v4, 4, v3
    v_bfe_u32 v5, v3, 2, 2
    v_lshl_add_u32 v6, v4, 3, v5
    v_lshlrev_b32 v6, 7, v6
    v_and_b32 v4, 1, v4
    v_lshlrev_b32 v4, 2, v4
    v_and_b32 v5, 2, v5
    v_or_b32 v4, v4, v5
    v_bfe_u32 v5, v3, 1, 1
    s_lshl_b32 s53, s12, 1
    v_add_u32 v5, s53, v5
    v_xor_b32 v4, v4, v5
    v_lshl_add_u32 v6, v4, 4, v6
    v_and_b32 v5, 1, v3
    v_lshl_add_u32 v6, v5, 3, v6
    v_add_u32 v7, 30720, v6
    ds_read_b64_tr_b16 v[64:65], v7 offset:0
    ds_read_b64_tr_b16 v[66:67], v7 offset:512
    ds_read_b64_tr_b16 v[68:69], v7 offset:4096
    ds_read_b64_tr_b16 v[70:71], v7 offset:4608
    ds_read_b64_tr_b16 v[72:73], v7 offset:8192
    ds_read_b64_tr_b16 v[74:75], v7 offset:8704
    ds_read_b64_tr_b16 v[76:77], v7 offset:12288
    ds_read_b64_tr_b16 v[78:79], v7 offset:12800
    ds_read_b64_tr_b16 v[80:81], v7 offset:16384
    ds_read_b64_tr_b16 v[82:83], v7 offset:16896
    ds_read_b64_tr_b16 v[84:85], v7 offset:20480
    ds_read_b64_tr_b16 v[86:87], v7 offset:20992
    ds_read_b64_tr_b16 v[88:89], v7 offset:24576
    ds_read_b64_tr_b16 v[90:91], v7 offset:25088
    ds_read_b64_tr_b16 v[92:93], v7 offset:28672
    ds_read_b64_tr_b16 v[94:95], v7 offset:29184
    ds_read_b64_tr_b16 v[96:97], v7 offset:32768
    ds_read_b64_tr_b16 v[98:99], v7 offset:33280
    ds_read_b64_tr_b16 v[100:101], v7 offset:36864
    ds_read_b64_tr_b16 v[102:103], v7 offset:37376
    ds_read_b64_tr_b16 v[104:105], v7 offset:40960
    ds_read_b64_tr_b16 v[106:107], v7 offset:41472
    ds_read_b64_tr_b16 v[108:109], v7 offset:45056
    ds_read_b64_tr_b16 v[110:111], v7 offset:45568
    ds_read_b64_tr_b16 v[112:113], v7 offset:49152
    ds_read_b64_tr_b16 v[114:115], v7 offset:49664
    ds_read_b64_tr_b16 v[116:117], v7 offset:53248
    ds_read_b64_tr_b16 v[118:119], v7 offset:53760
    v_lshlrev_b32 v24, 16, v48
    v_and_b32 v25, 0xffff0000, v48
    v_lshlrev_b32 v26, 16, v49
    v_and_b32 v27, 0xffff0000, v49
    v_sub_f32 v24, v24, v32
    v_sub_f32 v25, v25, v32
    v_sub_f32 v26, v26, v32
    v_sub_f32 v27, v27, v32
    v_cvt_pk_bf16_f32 v24, 0, v24
    v_cvt_pk_bf16_f32 v25, 0, v25
    v_cvt_pk_bf16_f32 v26, 0, v26
    v_cvt_pk_bf16_f32 v27, 0, v27
    v_mul_f32 v24, v34, v24
    v_mul_f32 v25, v34, v25
    v_mul_f32 v26, v34, v26
    v_mul_f32 v27, v34, v27
    v_cvt_pk_bf16_f32 v24, 0, v24
    v_cvt_pk_bf16_f32 v25, 0, v25
    v_cvt_pk_bf16_f32 v26, 0, v26
    v_cvt_pk_bf16_f32 v27, 0, v27
    v_lshlrev_b32 v5, 1, v9
    s_mov_b32 s53, 0x1000
L_pt_9:
    buffer_load_dwordx4 v[32:35], v5, s[8:11], s53 offen sc1
    buffer_load_dwordx4 v[36:39], v5, s[8:11], s53 offen offset:1792 sc1
    s_waitcnt vmcnt(0)
    v_xor_b32 v32, s14, v32
    v_xor_b32 v33, s15, v33
    v_xor_b32 v34, s14, v34
    v_xor_b32 v35, s15, v35
    v_xor_b32 v36, s14, v36
    v_xor_b32 v37, s15, v37
    v_xor_b32 v38, s14, v38
    v_xor_b32 v39, s15, v39
    v_or_b32 v4, v32, v33
    v_or3_b32 v4, v4, v34, v35
    v_or3_b32 v4, v4, v36, v37
    v_or3_b32 v4, v4, v38, v39
    v_and_b32 v4, 0xffff, v4
    v_cmp_ne_u32 vcc, 0, v4
    s_cbranch_vccz L_pt_9_ok
    s_add_u32 s60, s60, 1
    s_cmp_lt_u32 s60, 0x200000
    s_cbranch_scc1 L_pt_9
    s_branch L_exit
L_pt_9_ok:
    v_add_f32 v36, 1.0, v36
    v_add_f32 v37, 1.0, v37
    v_add_f32 v38, 1.0, v38
    v_add_f32 v39, 1.0, v39
    v_cvt_pk_bf16_f32 v36, 0, v36
    v_cvt_pk_bf16_f32 v37, 0, v37
    v_cvt_pk_bf16_f32 v38, 0, v38
    v_cvt_pk_bf16_f32 v39, 0, v39
    v_mul_f32 v36, v36, v24
    v_mul_f32 v37, v37, v25
    v_mul_f32 v38, v38, v26
    v_mul_f32 v39, v39, v27
    v_cvt_pk_bf16_f32 v36, 0, v36
    v_cvt_pk_bf16_f32 v37, 0, v37
    v_cvt_pk_bf16_f32 v38, 0, v38
    v_cvt_pk_bf16_f32 v39, 0, v39
    v_add_f32 v36, v36, v32
    v_add_f32 v37, v37, v33
    v_add_f32 v38, v38, v34
    v_add_f32 v39, v39, v35
    v_cvt_pk_bf16_f32 v20, v36, v37
    v_cvt_pk_bf16_f32 v21, v38, v39
    ds_write_b64 v9, v[20:21] offset:2048
    s_mov_b64 exec, 1
    v_mov_b32 v4, 0
    v_mov_b32 v5, 1
    ds_add_u32 v4, v5 offset:0
L_hb_10:
    ds_read_b32 v6, v4 offset:0
    s_waitcnt lgkmcnt(0)
    v_cmp_le_u32 vcc, s68, v6
    s_cbranch_vccnz L_hb_10_ok
    s_add_u32 s60, s60, 1
    s_cmp_lt_u32 s60, 0x200000
    s_cbranch_scc1 L_hb_10
    s_branch L_exit
L_hb_10_ok:
    s_mov_b64 exec, -1
    s_add_u32 s68, s68, 4
L_PG:
    v_lshrrev_b32 v10, 4, v3
    v_lshl_add_u32 v10, v10, 4, s59
    v_and_b32 v11, 1, v3
    v_lshlrev_b32 v11, 15, v11
    v_xor_b32 v11, s14, v11
    v_lshlrev_b32 v5, 2, v3
    s_lshl_b32 s53, s12, 6
    s_add_u32 s56, s56, s53
    s_waitcnt lgkmcnt(0)
    ds_read_b128 v[160:163], v10 offset:2048
    ds_read_b128 v[164:167], v10 offset:2112
    ds_read_b128 v[168:171], v10 offset:2176
    ds_read_b128 v[172:175], v10 offset:2240
    ds_read_b128 v[176:179], v10 offset:2304
    ds_read_b128 v[180:183], v10 offset:2368
    ds_read_b128 v[184:187], v10 offset:2432
    ds_read_b128 v[188:191], v10 offset:2496
    ds_read_b128 v[192:195], v10 offset:2560
    ds_read_b128 v[196:199], v10 offset:2624
    ds_read_b128 v[200:203], v10 offset:2688
    ds_read_b128 v[204:207], v10 offset:2752
    ds_read_b128 v[208:211], v10 offset:2816
    ds_read_b128 v[212:215], v10 offset:2880
    s_waitcnt lgkmcnt(13)
    v_mfma_f32_16x16x32_bf16 v[16:19], v[160:163], v[64:67], 0
    s_waitcnt lgkmcnt(12)
    v_mfma_f32_16x16x32_bf16 v[16:19], v[164:167], v[68:71], v[16:19]
    s_waitcnt lgkmcnt(11)
    v_mfma_f32_16x16x32_bf16 v[16:19], v[168:171], v[72:75], v[16:19]
    s_waitcnt lgkmcnt(10)
    v_mfma_f32_16x16x32_bf16 v[16:19], v[172:175], v[76:79], v[16:19]
    s_waitcnt lgkmcnt(9)
    v_mfma_f32_16x16x32_bf16 v[16:19], v[176:179], v[80:83], v[16:19]
    s_waitcnt lgkmcnt(8)
    v_mfma_f32_16x16x32_bf16 v[16:19], v[180:183], v[84:87], v[16:19]
    s_waitcnt lgkmcnt(7)
    v_mfma_f32_16x16x32_bf16 v[16:19], v[184:187], v[88:91], v[16:19]
    s_waitcnt lgkmcnt(6)
    v_mfma_f32_16x16x32_bf16 v[16:19], v[188:191], v[92:95], v[16:19]
    s_waitcnt lgkmcnt(5)
    v_mfma_f32_16x16x32_bf16 v[16:19], v[192:195], v[96:99], v[16:19]
    s_waitcnt lgkmcnt(4)
    v_mfma_f32_16x16x32_bf16 v[16:19], v[196:199], v[100:103], v[16:19]
    s_waitcnt lgkmcnt(3)
    v_mfma_f32_16x16x32_bf16 v[16:19], v[200:203], v[104:107], v[16:19]
    s_waitcnt lgkmcnt(2)
    v_mfma_f32_16x16x32_bf16 v[16:19], v[204:207], v[108:111], v[16:19]
    s_waitcnt lgkmcnt(1)
    v_mfma_f32_16x16x32_bf16 v[16:19], v[208:211], v[112:115], v[16:19]
    s_waitcnt lgkmcnt(0)
    v_mfma_f32_16x16x32_bf16 v[16:19], v[212:215], v[116:119], v[16:19]
    s_nop 7
    v_cvt_pk_bf16_f32 v16, 0, v16
    v_or_b32 v16, v16, v11
    s_mov_b64 exec, 0xffff
    buffer_store_dword v16, v5, s[8:11], s56 offen sc1
    s_mov_b64 exec, -1
    s_cmp_eq_u32 s69, 0
    s_cbranch_scc0 L_MP
L_Q:
    s_cmp_eq_u32 s12, 0
    s_cbranch_scc0 L_B1
    v_mov_b32 v4, 0
L_lw_11:
    ds_read_b32 v6, v4 offset:12
    s_waitcnt lgkmcnt(0)
    v_cmp_le_u32 vcc, 1, v6
    s_cbranch_vccnz L_lw_11_ok
    s_sleep 2
    s_add_u32 s60, s60, 1
    s_cmp_lt_u32 s60, 0x200000
    s_cbranch_scc1 L_lw_11
    s_branch L_exit
L_lw_11_ok:
    v_lshlrev_b32 v5, 4, v3
    s_lshl_b32 s53, s4, 11
    s_add_u32 s53, s53, 0x4000
L_pt_12:
    buffer_load_dwordx4 v[32:35], v5, s[8:11], s53 offen sc1
    buffer_load_dwordx4 v[36:39], v5, s[8:11], s53 offen offset:1024 sc1
    s_waitcnt vmcnt(0)
    v_xor_b32 v32, s14, v32
    v_xor_b32 v33, s15, v33
    v_xor_b32 v34, s14, v34
    v_xor_b32 v35, s15, v35
    v_xor_b32 v36, s14, v36
    v_xor_b32 v37, s15, v37
    v_xor_b32 v38, s14, v38
    v_xor_b32 v39, s15, v39
    v_or_b32 v4, v32, v33
    v_or3_b32 v4, v4, v34, v35
    v_or3_b32 v4, v4, v36, v37
    v_or3_b32 v4, v4, v38, v39
    v_and_b32 v4, 0xffff, v4
    v_cmp_ne_u32 vcc, 0, v4
    s_cbranch_vccz L_pt_12_ok
    s_add_u32 s60, s60, 1
    s_cmp_lt_u32 s60, 0x200000
    s_cbranch_scc1 L_pt_12
    s_branch L_exit
L_pt_12_ok:
    s_mov_b32 s53, 0x07060302
    v_perm_b32 v20, v33, v32, s53
    v_perm_b32 v21, v35, v34, s53
    v_perm_b32 v22, v37, v36, s53
    v_perm_b32 v23, v39, v38, s53
    v_lshlrev_b32 v5, 3, v3
    ds_write_b64 v5, v[20:21] offset:256
    ds_write_b64 v5, v[22:23] offset:768
L_B1:
    s_waitcnt lgkmcnt(0)
    s_barrier
    v_mov_b32 v230, 0
    v_mov_b32 v8, 0
    v_mov_b32 v9, 0
    v_mov_b32 v12, 0
    v_and_b32 v0, 1, v3
    v_lshlrev_b32 v0, 7, v0
    v_xor_b32 v0, s6, v0
    v_bfe_u32 v2, v3, 2, 1
    v_lshlrev_b32 v2, 7, v2
    v_xor_b32 v2, s6, v2
    s_mov_b32 s50, 0xffffff00
    s_cmp_lt_u32 s5, 18
    s_cbranch_scc1 L_MP
    s_cmp_ge_u32 s5, 24
    s_cbranch_scc1 L_MP
    s_sub_u32 s53, s5, 21
    s_cmp_lt_u32 s53, 2
    s_cbranch_scc1 L_MP
    s_cmp_lt_u32 s4, 7
    s_cbranch_scc0 L_MP
    s_min_u32 s53, s5, 21
    s_lshl_b32 s13, s4, 2
    s_add_u32 s13, s13, s53
    s_sub_u32 s13, s13, 4
    s_mov_b32 s69, 1
    s_mov_b64 s[40:41], s[34:35]
    s_mov_b32 s42, 896
    v_min_u32 v5, 55, v3
    v_lshlrev_b32 v5, 4, v5
    buffer_load_dwordx4 v[20:23], v5, s[40:43], 0 offen
    s_branch L_P1a
L_MP:
    v_mov_b32 v4, 0
L_lw_13:
    ds_read_b32 v6, v4 offset:4
    s_waitcnt lgkmcnt(0)
    v_cmp_le_u32 vcc, 4, v6
    s_cbranch_vccnz L_lw_13_ok
    s_sleep 16
    s_add_u32 s60, s60, 1
    s_cmp_lt_u32 s60, 0x200000
    s_cbranch_scc1 L_lw_13
    s_branch L_exit
L_lw_13_ok:
    s_cmp_eq_u32 s12, 0
    s_cbranch_scc0 L_mlp_14
    v_lshlrev_b32 v5, 2, v3
    ds_read_b32 v7, v5 offset:64
    s_mul_i32 s53, s4, 0x18000
    s_lshl_b32 s54, s5, 7
    s_add_u32 s54, s54, s53
    s_add_u32 s54, s54, 0x50000
    v_bfe_u32 v6, v3, 1, 1
    v_lshlrev_b32 v6, 7, v6
    v_xor_b32 v6, s6, v6
    s_waitcnt lgkmcnt(0)
    s_mov_b64 exec, 0xaaaa
    v_and_or_b32 v7, v7, s50, v6
    s_mov_b64 exec, 0xffff
    buffer_store_dword v7, v5, s[8:11], s54 offen sc1
    s_mov_b64 exec, -1
L_mlp_14:
    s_cmp_lt_u32 s5, 21
    s_cbranch_scc0 L_S3
    s_cmp_lt_u32 s5, 14
    s_cbranch_scc0 L_S2
    s_and_b32 s53, s5, 1
    s_lshl_b32 s13, s4, 1
    s_add_u32 s13, s13, s53
    s_mul_i32 s52, s13, 229376
    s_lshr_b32 s53, s5, 1
    s_lshl_b32 s53, s53, 7
    s_add_u32 s52, s52, s53
    s_mov_b64 s[40:41], s[24:25]
    s_mov_b32 s42, 3670016
    s_mov_b32 s51, 896
    s_mov_b32 s57, 3
    s_mov_b32 s58, 8
    v_lshrrev_b32 v6, s57, v3
    v_mul_lo_u32 v17, v6, s51
    v_lshlrev_b32 v7, s57, v6
    v_sub_u32 v7, v3, v7
    s_cmp_eq_u32 s57, 3
    s_cselect_b32 s59, 2, 0
    v_and_b32 v6, s59, v6
    v_xor_b32 v7, v7, v6
    v_lshl_add_u32 v17, v7, 4, v17
    s_lshl_b32 s59, s59, 5
    s_sub_u32 s53, 6, s57
    s_lshl_b32 s53, s51, s53
    s_mul_i32 s54, s12, s58
    s_mul_i32 s55, s54, s53
    s_add_u32 s52, s52, s55
    s_lshl_b32 s54, s54, 10
    s_add_u32 m0, s54, 30720
    s_mov_b32 s55, s58
L_dma_15:
    s_waitcnt vmcnt(0)
    buffer_load_dwordx4 v17, s[40:43], s52 offen  lds
    s_add_u32 s52, s52, s53
    s_add_u32 m0, m0, 1024
    v_xor_b32 v17, s59, v17
    s_sub_u32 s55, s55, 1
    s_cmp_lg_u32 s55, 0
    s_cbranch_scc1 L_dma_15
    s_waitcnt vmcnt(0)
    s_mov_b64 exec, 1
    v_mov_b32 v4, 0
    v_mov_b32 v5, 1
    ds_add_u32 v4, v5 offset:0
L_hb_16:
    ds_read_b32 v6, v4 offset:0
    s_waitcnt lgkmcnt(0)
    v_cmp_le_u32 vcc, s68, v6
    s_cbranch_vccnz L_hb_16_ok
    s_add_u32 s60, s60, 1
    s_cmp_lt_u32 s60, 0x200000
    s_cbranch_scc1 L_hb_16
    s_branch L_exit
L_hb_16_ok:
    s_mov_b64 exec, -1
    s_add_u32 s68, s68, 4
    v_lshrrev_b32 v4, 4, v3
    v_bfe_u32 v5, v3, 2, 2
    v_lshl_add_u32 v6, v4, 3, v5
    v_lshlrev_b32 v6, 7, v6
    v_and_b32 v4, 1, v4
    v_lshlrev_b32 v4, 2, v4
    v_and_b32 v5, 2, v5
    v_or_b32 v4, v4, v5
    v_bfe_u32 v5, v3, 1, 1
    s_lshl_b32 s53, s12, 1
    v_add_u32 v5, s53, v5
    v_xor_b32 v4, v4, v5
    v_lshl_add_u32 v6, v4, 4, v6
    v_and_b32 v5, 1, v3
    v_lshl_add_u32 v6, v5, 3, v6
    v_add_u32 v7, 30720, v6
    ds_read_b64_tr_b16 v[64:65], v7 offset:0
    ds_read_b64_tr_b16 v[66:67], v7 offset:512
    ds_read_b64_tr_b16 v[68:69], v7 offset:4096
    ds_read_b64_tr_b16 v[70:71], v7 offset:4608
    ds_read_b64_tr_b16 v[72:73], v7 offset:8192
    ds_read_b64_tr_b16 v[74:75], v7 offset:8704
    ds_read_b64_tr_b16 v[76:77], v7 offset:12288
    ds_read_b64_tr_b16 v[78:79], v7 offset:12800
    ds_read_b64_tr_b16 v[80:81], v7 offset:16384
    ds_read_b64_tr_b16 v[82:83], v7 offset:16896
    ds_read_b64_tr_b16 v[84:85], v7 offset:20480
    ds_read_b64_tr_b16 v[86:87], v7 offset:20992
    ds_read_b64_tr_b16 v[88:89], v7 offset:24576
    ds_read_b64_tr_b16 v[90:91], v7 offset:25088
    ds_read_b64_tr_b16 v[92:93], v7 offset:28672
    ds_read_b64_tr_b16 v[94:95], v7 offset:29184
    v_lshlrev_b32 v8, 4, v3
    s_mul_i32 s62, s4, 0x18000
    s_and_b32 s54, s5, 1
    s_lshl_b32 s54, s54, 15
    s_add_u32 s62, s62, s54
    s_lshl_b32 s54, s12, 13
    s_add_u32 s62, s62, s54
    s_add_u32 s62, s62, 0x40000
    s_add_u32 s63, s62, 4096
    s_mul_i32 s55, s12, 576
    v_lshl_add_u32 v10, v3, 3, s55
    v_and_b32 v11, 3, v3
    v_mul_u32_u24 v11, 576, v11
    v_lshrrev_b32 v12, 4, v3
    v_lshl_add_u32 v11, v12, 4, v11
    s_mul_i32 s56, s13, 1792
    s_lshr_b32 s55, s5, 1
    s_lshl_b32 s55, s55, 8
    s_add_u32 s56, s56, s55
    s_lshl_b32 s55, s12, 6
    s_add_u32 s56, s56, s55
    s_add_u32 s56, s56, 0x10000
    v_lshlrev_b32 v12, 2, v3
    s_branch L_ML
L_S2:
    s_mul_i32 s13, s4, 7
    s_add_u32 s13, s13, s5
    s_sub_u32 s13, s13, 14
    v_lshlrev_b32 v8, 4, v3
    v_min_u32 v9, 47, v3
    v_lshlrev_b32 v9, 4, v9
    v_add_u32 v9, 1024, v9
    v_lshrrev_b32 v10, 1, v8
    v_lshrrev_b32 v11, 1, v9
    buffer_load_dwordx2 v[20:21], v10, s[44:47], 0 offen
    buffer_load_dwordx2 v[22:23], v11, s[44:47], 0 offen
    s_mov_b32 s53, 0x1e00
L_pt_17:
    s_waitcnt vmcnt(1)
    buffer_load_dwordx4 v[224:227], v8, s[8:11], s53 offen offset:0 sc1
    s_waitcnt vmcnt(1)
    buffer_load_dwordx4 v[228:231], v9, s[8:11], s53 offen offset:0 sc1
    s_waitcnt vmcnt(1)
    buffer_load_dwordx4 v[232:235], v8, s[8:11], s53 offen offset:1792 sc1
    s_waitcnt vmcnt(1)
    buffer_load_dwordx4 v[236:239], v9, s[8:11], s53 offen offset:1792 sc1
    s_waitcnt vmcnt(1)
    buffer_load_dwordx4 v[240:243], v8, s[8:11], s53 offen offset:3584 sc1
    s_waitcnt vmcnt(1)
    buffer_load_dwordx4 v[244:247], v9, s[8:11], s53 offen offset:3584 sc1
    s_waitcnt vmcnt(0)
    v_xor_b32 v224, s14, v224
    v_xor_b32 v225, s15, v225
    v_xor_b32 v226, s14, v226
    v_xor_b32 v227, s15, v227
    v_xor_b32 v228, s14, v228
    v_xor_b32 v229, s15, v229
    v_xor_b32 v230, s14, v230
    v_xor_b32 v231, s15, v231
    v_xor_b32 v232, s14, v232
    v_xor_b32 v233, s15, v233
    v_xor_b32 v234, s14, v234
    v_xor_b32 v235, s15, v235
    v_xor_b32 v236, s14, v236
    v_xor_b32 v237, s15, v237
    v_xor_b32 v238, s14, v238
    v_xor_b32 v239, s15, v239
    v_xor_b32 v240, s14, v240
    v_xor_b32 v241, s15, v241
    v_xor_b32 v242, s14, v242
    v_xor_b32 v243, s15, v243
    v_xor_b32 v244, s14, v244
    v_xor_b32 v245, s15, v245
    v_xor_b32 v246, s14, v246
    v_xor_b32 v247, s15, v247
    v_or_b32 v4, v224, v225
    v_or3_b32 v4, v4, v226, v227
    v_or3_b32 v4, v4, v228, v229
    v_or3_b32 v4, v4, v230, v231
    v_or3_b32 v4, v4, v232, v233
    v_or3_b32 v4, v4, v234, v235
    v_or3_b32 v4, v4, v236, v237
    v_or3_b32 v4, v4, v238, v239
    v_or3_b32 v4, v4, v240, v241
    v_or3_b32 v4, v4, v242, v243
    v_or3_b32 v4, v4, v244, v245
    v_or3_b32 v4, v4, v246, v247
    v_and_b32 v4, 0xffff, v4
    v_cmp_ne_u32 vcc, 0, v4
    s_cbranch_vccz L_pt_17_ok
    s_sleep 64
    s_add_u32 s60, s60, 1
    s_cmp_lt_u32 s60, 0x200000
    s_cbranch_scc1 L_pt_17
    s_branch L_exit
L_pt_17_ok:
    v_lshlrev_b32 v248, 16, v20
    v_and_b32 v249, 0xffff0000, v20
    v_lshlrev_b32 v250, 16, v21
    v_and_b32 v251, 0xffff0000, v21
    v_lshlrev_b32 v252, 16, v22
    v_and_b32 v253, 0xffff0000, v22
    v_lshlrev_b32 v254, 16, v23
    v_and_b32 v255, 0xffff0000, v23
    v_add_f32 v240, 1.0, v240
    v_add_f32 v241, 1.0, v241
    v_add_f32 v242, 1.0, v242
    v_add_f32 v243, 1.0, v243
    v_add_f32 v244, 1.0, v244
    v_add_f32 v245, 1.0, v245
    v_add_f32 v246, 1.0, v246
    v_add_f32 v247, 1.0, v247
    v_cvt_pk_bf16_f32 v240, 0, v240
    v_cvt_pk_bf16_f32 v241, 0, v241
    v_cvt_pk_bf16_f32 v242, 0, v242
    v_cvt_pk_bf16_f32 v243, 0, v243
    v_cvt_pk_bf16_f32 v244, 0, v244
    v_cvt_pk_bf16_f32 v245, 0, v245
    v_cvt_pk_bf16_f32 v246, 0, v246
    v_cvt_pk_bf16_f32 v247, 0, v247
    v_cvt_pk_bf16_f32 v20, v240, v241
    v_cvt_pk_bf16_f32 v21, v242, v243
    v_cvt_pk_bf16_f32 v22, v244, v245
    v_cvt_pk_bf16_f32 v23, v246, v247
    v_cvt_pk_bf16_f32 v24, v232, v233
    v_cvt_pk_bf16_f32 v25, v234, v235
    v_cvt_pk_bf16_f32 v26, v236, v237
    v_cvt_pk_bf16_f32 v27, v238, v239
    ds_write_b64 v10, v[20:21] offset:28672
    ds_write_b64 v11, v[22:23] offset:28672
    ds_write_b64 v10, v[24:25] offset:29632
    ds_write_b64 v11, v[26:27] offset:29632
    s_cmp_eq_u32 s12, 0
    s_cselect_b32 s53, 1.0, 0
    v_mul_f32 v232, v248, v240
    v_mul_f32 v233, v249, v241
    v_mul_f32 v234, v250, v242
    v_mul_f32 v235, v251, v243
    v_mul_f32 v236, v252, v244
    v_mul_f32 v237, v253, v245
    v_mul_f32 v238, v254, v246
    v_mul_f32 v239, v255, v247
    v_mul_f32 v232, s53, v232
    v_mul_f32 v233, s53, v233
    v_mul_f32 v234, s53, v234
    v_mul_f32 v235, s53, v235
    v_mul_f32 v236, s53, v236
    v_mul_f32 v237, s53, v237
    v_mul_f32 v238, s53, v238
    v_mul_f32 v239, s53, v239
    v_mul_f32 v240, v224, v240
    v_mul_f32 v241, v225, v241
    v_mul_f32 v242, v226, v242
    v_mul_f32 v243, v227, v243
    v_mul_f32 v244, v228, v244
    v_mul_f32 v245, v229, v245
    v_mul_f32 v246, v230, v246
    v_mul_f32 v247, v231, v247
    s_mov_b32 exec_lo, 0
    s_mov_b32 exec_hi, 0xffff0000
    v_mov_b32 v228, 0
    v_mov_b32 v252, 0
    v_mov_b32 v229, 0
    v_mov_b32 v253, 0
    v_mov_b32 v230, 0
    v_mov_b32 v254, 0
    v_mov_b32 v231, 0
    v_mov_b32 v255, 0
    s_mov_b64 exec, -1
    s_branch L_ML
L_S3:
    s_sub_u32 s13, s5, 30
    s_lshl_b32 s13, s13, 3
    s_add_u32 s13, s13, s4
    s_cmp_eq_u32 s12, 2
    s_cselect_b32 s13, s13, 14
    s_cmp_lt_u32 s13, 14
    s_cbranch_scc0 L_ML
    v_bfe_u32 v4, v3, 4, 1
    v_lshrrev_b32 v5, 5, v3
    v_lshl_add_u32 v4, v4, 1, v5
    v_and_b32 v5, 7, v3
    v_lshl_add_u32 v4, v5, 2, v4
    s_lshl_b32 s53, s13, 5
    v_add_u32 v4, s53, v4
    v_lshlrev_b32 v230, 1, v4
    v_lshlrev_b32 v5, 2, v4
    v_and_b32 v6, 1, v4
    v_lshlrev_b32 v6, 15, v6
    v_xor_b32 v6, s14, v6
    buffer_load_ushort v226, v230, s[44:47], 0 offen
    s_mov_b32 s53, 0x1e00
    s_mov_b32 s54, 0x3300
L_e3m_18:
    buffer_load_dword v224, v5, s[8:11], s53 offen sc1
    buffer_load_dword v225, v5, s[8:11], s54 offen sc1
    s_waitcnt vmcnt(0)
    v_xor_b32 v224, v224, v6
    v_xor_b32 v225, v225, v6
    v_or_b32 v4, v224, v225
    v_and_b32 v4, 0xffff, v4
    v_cmp_ne_u32 vcc, 0, v4
    s_cbranch_vccz L_e3m_18_ok
    s_sleep 64
    s_add_u32 s60, s60, 1
    s_cmp_lt_u32 s60, 0x200000
    s_cbranch_scc1 L_e3m_18
    s_branch L_exit
L_e3m_18_ok:
    v_lshlrev_b32 v226, 16, v226
L_ML:
    s_cmp_lt_u32 s12, 2
    s_cbranch_scc0 L_B2
    s_mul_i32 s57, s4, 0x18000
    s_add_u32 s57, s57, 0x40000
    s_add_u32 s53, s57, 0x10000
    v_mov_b32 v4, 0
L_lw_19:
    ds_read_b32 v6, v4 offset:8
    s_waitcnt lgkmcnt(0)
    v_cmp_le_u32 vcc, 1, v6
    s_cbranch_vccnz L_lw_19_ok
    s_sleep 16
    s_add_u32 s60, s60, 1
    s_cmp_lt_u32 s60, 0x200000
    s_cbranch_scc1 L_lw_19
    s_branch L_exit
L_lw_19_ok:
    v_lshrrev_b32 v5, 1, v3
    v_lshlrev_b32 v5, 7, v5
    v_and_b32 v6, 1, v3
    v_lshl_add_u32 v5, v6, 4, v5
    s_lshl_b32 s54, s12, 5
    s_add_u32 s53, s53, s54
L_p8_20:
    buffer_load_dwordx4 v[32:35], v5, s[8:11], s53 offen sc1
    s_waitcnt vmcnt(0)
    v_xor_b32 v4, s6, v33
    v_bitop3_b32 v4, v4, v35, s7 bitop3:0xf6
    v_and_b32 v4, 0xff, v4
    v_cmp_ne_u32 vcc, 0, v4
    s_cbranch_vccz L_p8_20_ok
    s_sleep 16
    s_add_u32 s60, s60, 1
    s_cmp_lt_u32 s60, 0x200000
    s_cbranch_scc1 L_p8_20
    s_branch L_exit
L_p8_20_ok:
    v_lshlrev_b32 v5, 4, v3
    s_lshl_b32 s58, s12, 5
    s_add_u32 s58, s58, s5
    s_lshl_b32 s58, s58, 10
    s_add_u32 s58, s58, s57
    buffer_load_dwordx4 v[40:43], v5, s[8:11], s58 offen sc1
    s_getreg_b32 s55, hwreg(HW_REG_XCC_ID, 0, 4)
    v_xor_b32 v36, s55, v32
    v_bitop3_b32 v36, v36, v34, s55 bitop3:0xf6
    v_and_b32 v36, 15, v36
    v_cmp_ne_u32 s[48:49], 0, v36
    v_max_f32 v36, v32, v34
    s_nop 1
    v_max_f32_dpp v36, v36, v36 row_ror:8 row_mask:0xf bank_mask:0xf
    s_nop 1
    v_max_f32_dpp v36, v36, v36 row_ror:4 row_mask:0xf bank_mask:0xf
    s_nop 1
    v_max_f32_dpp v36, v36, v36 row_ror:2 row_mask:0xf bank_mask:0xf
    s_nop 1
    v_max_f32_dpp v36, v36, v36 row_ror:1 row_mask:0xf bank_mask:0xf
    v_mov_b32 v37, v36
    s_nop 1
    v_permlane16_swap_b32 v36, v37
    v_max_f32 v36, v36, v37
    v_mov_b32 v37, v36
    s_nop 1
    v_permlane32_swap_b32 v36, v37
    v_max_f32 v36, v36, v37
    v_sub_f32 v32, v32, v36
    v_sub_f32 v34, v34, v36
    v_exp_f32 v32, v32
    v_exp_f32 v34, v34
    v_mul_f32 v36, v32, v33
    v_fmac_f32 v36, v34, v35
    s_nop 1
    v_add_f32_dpp v36, v36, v36 row_ror:8 row_mask:0xf bank_mask:0xf
    s_nop 1
    v_add_f32_dpp v36, v36, v36 row_ror:4 row_mask:0xf bank_mask:0xf
    s_nop 1
    v_add_f32_dpp v36, v36, v36 row_ror:2 row_mask:0xf bank_mask:0xf
    s_nop 1
    v_add_f32_dpp v36, v36, v36 row_ror:1 row_mask:0xf bank_mask:0xf
    v_mov_b32 v37, v36
    s_nop 1
    v_permlane16_swap_b32 v36, v37
    v_add_f32 v36, v36, v37
    v_mov_b32 v37, v36
    s_nop 1
    v_permlane32_swap_b32 v36, v37
    v_add_f32 v36, v36, v37
    v_rcp_f32 v36, v36
    s_lshl_b32 s53, s5, 1
    s_add_u32 s54, s53, 1
    v_mul_f32 v32, v32, v36
    v_mul_f32 v34, v34, v36
    v_readlane_b32 s64, v32, s53
    v_readlane_b32 s65, v34, s53
    v_readlane_b32 s66, v32, s54
    v_readlane_b32 s67, v34, s54
    s_lshl_b32 s53, s12, 10
    v_add_u32 v7, s53, v5
    v_mov_b32 v48, s64
    v_mov_b32 v49, s64
    v_mov_b32 v50, s65
    v_mov_b32 v51, s65
    v_mov_b32 v52, s66
    v_mov_b32 v53, s66
    v_mov_b32 v54, s67
    v_mov_b32 v55, s67
    s_cmp_eq_u64 s[48:49], 0
    s_waitcnt vmcnt(0) lgkmcnt(0)
    s_barrier
    ds_read_b128 v[32:35], v7 offset:6144
    ds_read_b128 v[36:39], v7 offset:8192
    ds_read_b128 v[40:43], v7 offset:10240
    ds_read_b128 v[44:47], v7 offset:12288
    s_waitcnt lgkmcnt(3)
    v_pk_mul_f32 v[20:21], v[32:33], v[48:49]
    v_pk_mul_f32 v[22:23], v[34:35], v[48:49]
    s_waitcnt lgkmcnt(2)
    v_pk_fma_f32 v[20:21], v[36:37], v[50:51], v[20:21]
    v_pk_fma_f32 v[22:23], v[38:39], v[50:51], v[22:23]
    s_waitcnt lgkmcnt(1)
    v_pk_fma_f32 v[20:21], v[40:41], v[52:53], v[20:21]
    v_pk_fma_f32 v[22:23], v[42:43], v[52:53], v[22:23]
    s_waitcnt lgkmcnt(0)
    v_pk_fma_f32 v[20:21], v[44:45], v[54:55], v[20:21]
    v_pk_fma_f32 v[22:23], v[46:47], v[54:55], v[22:23]
    v_and_or_b32 v20, v20, s50, v0
    s_cbranch_scc0 L_far
    buffer_store_dwordx4 v[20:23], v5, s[8:11], s58 offen
    s_branch L_E
L_far:
    buffer_store_dwordx4 v[20:23], v5, s[8:11], s58 offen sc1
    s_branch L_E
L_B2:
    s_waitcnt vmcnt(0) lgkmcnt(0)
    s_barrier
L_E:
    s_cmp_lt_u32 s5, 14
    s_cbranch_scc1 L_E1
    s_cmp_lt_u32 s5, 21
    s_cbranch_scc1 L_E2
    v_lshlrev_b32 v6, 4, v3
    v_lshrrev_b32 v8, 5, v3
    v_and_b32 v9, 31, v3
    v_lshlrev_b32 v9, 4, v9
    v_mul_u32_u24 v7, 3584, v8
    v_add_u32 v7, v7, v9
    s_sub_u32 s55, s5, 21
    s_lshl_b32 s55, s55, 2
    s_add_u32 s55, s55, s12
    s_mul_i32 s54, s4, 448
    s_and_b32 s54, s54, 0xffffff80
    s_mov_b64 s[40:41], s[30:31]
    s_mov_b32 s42, 1605632
    s_mul_i32 s53, s55, 7168
    s_add_u32 s52, s54, s53
L_pl_21:
    buffer_load_dwordx4 v[24:27], v7, s[40:43], s52 offen
    s_add_u32 s52, s52, 315392
    s_add_u32 s55, s55, 44
    s_cmp_lt_u32 s55, 224
    s_cbranch_scc1 L_pl_21
    s_sub_u32 s55, s55, 224
    s_mul_i32 s54, s4, 200704
    s_mov_b64 s[40:41], s[32:33]
    s_mov_b32 s42, 1605632
    s_mul_i32 s53, s55, 1024
    s_add_u32 s52, s54, s53
L_pl_22:
    buffer_load_dwordx4 v[24:27], v6, s[40:43], s52 offen
    s_add_u32 s52, s52, 45056
    s_add_u32 s55, s55, 44
    s_cmp_lt_u32 s55, 196
    s_cbranch_scc1 L_pl_22
    s_sub_u32 s55, s55, 196
    s_cmp_lt_u32 s13, 14
    s_cbranch_scc0 L_exit
    v_lshrrev_b32 v4, 3, v3
    v_mul_u32_u24 v4, 1792, v4
    v_and_b32 v5, 7, v3
    v_lshl_add_u32 v5, v5, 4, v4
    s_lshl_b32 s53, s13, 7
    s_add_u32 s54, s53, 0x10000
    s_add_u32 s55, s54, 14336
    s_add_u32 s62, s53, 0x17000
    s_add_u32 s63, s53, 0x1a800
    s_add_u32 s64, s53, 0x1e000
    s_add_u32 s65, s53, 0x21800
    s_add_u32 s66, s53, 0x25000
    s_add_u32 s67, s53, 0x28800
    s_add_u32 s68, s53, 0x2c000
    s_mov_b32 s44, s38
    s_mov_b32 s45, s39
    s_mov_b32 s46, 0x380
    s_mov_b32 s47, 0x20000
    s_mul_i32 s52, s4, 0x18000
    s_add_u32 s52, s52, 0x40000
    v_and_b32 v6, 31, v3
    v_lshlrev_b32 v6, 10, v6
    s_mov_b32 exec_hi, 0
L_p8_23:
    buffer_load_dword v18, v6, s[8:11], s52 offen sc1
    s_waitcnt vmcnt(0)
    v_xor_b32 v4, s6, v18
    v_and_b32 v4, 0xff, v4
    v_cmp_ne_u32 vcc, 0, v4
    s_cbranch_vccz L_p8_23_ok
    s_sleep 1
    s_add_u32 s60, s60, 1
    s_cmp_lt_u32 s60, 0x200000
    s_cbranch_scc1 L_p8_23
    s_branch L_exit
L_p8_23_ok:
    s_mov_b32 exec_hi, -1
L_p8_24:
    buffer_load_dwordx4 v[32:35], v5, s[8:11], s54 offen sc1
    buffer_load_dwordx4 v[36:39], v5, s[8:11], s55 offen sc1
    s_waitcnt vmcnt(1)
    v_xor_b32 v4, v0, v32
    s_waitcnt vmcnt(0)
    v_bitop3_b32 v4, v4, v36, v0 bitop3:0xf6
    v_and_b32 v4, 0xff, v4
    v_cmp_ne_u32 vcc, 0, v4
    v_pk_add_f32 v[32:33], v[32:33], v[36:37]
    v_pk_add_f32 v[34:35], v[34:35], v[38:39]
    s_cbranch_vccz L_p8_24_ok
    s_sleep 1
    s_add_u32 s60, s60, 1
    s_cmp_lt_u32 s60, 0x200000
    s_cbranch_scc1 L_p8_24
    s_branch L_exit
L_p8_24_ok:
    s_cmp_eq_u32 s13, 0
    s_cbranch_scc0 L_ep_25
    v_mov_b32 v6, 0
    v_mov_b32 v7, s61
    s_mov_b64 exec, 1
    buffer_store_dword v7, v6, s[8:11], 0 offen sc1
    s_mov_b64 exec, -1
L_ep_25:
    v_permlane32_swap_b32 v32, v33
    v_permlane32_swap_b32 v34, v35
    v_add_f32 v32, v32, v33
    v_add_f32 v34, v34, v35
    s_nop 1
    v_permlane16_swap_b32 v32, v34
    v_add_f32 v32, v32, v34
    s_nop 1
    v_add_f32_dpp v32, v32, v32 row_ror:8 row_mask:0xf bank_mask:0xf
    v_fmac_f32 v226, v224, v32
    buffer_load_dwordx4 v[32:35], v5, s[8:11], s62 offen sc1
    buffer_load_dwordx4 v[36:39], v5, s[8:11], s63 offen sc1
    buffer_load_dwordx4 v[40:43], v5, s[8:11], s64 offen sc1
    buffer_load_dwordx4 v[44:47], v5, s[8:11], s65 offen sc1
    buffer_load_dwordx4 v[48:51], v5, s[8:11], s66 offen sc1
    buffer_load_dwordx4 v[52:55], v5, s[8:11], s67 offen sc1
    buffer_load_dwordx4 v[56:59], v5, s[8:11], s68 offen sc1
L_e3p:
    buffer_load_dwordx4 v[64:67], v5, s[8:11], s62 offen sc1
    buffer_load_dwordx4 v[68:71], v5, s[8:11], s63 offen sc1
    buffer_load_dwordx4 v[72:75], v5, s[8:11], s64 offen sc1
    buffer_load_dwordx4 v[76:79], v5, s[8:11], s65 offen sc1
    buffer_load_dwordx4 v[80:83], v5, s[8:11], s66 offen sc1
    buffer_load_dwordx4 v[84:87], v5, s[8:11], s67 offen sc1
    buffer_load_dwordx4 v[88:91], v5, s[8:11], s68 offen sc1
    s_waitcnt vmcnt(13)
    v_xor_b32 v4, v0, v32
    s_waitcnt vmcnt(12)
    v_bitop3_b32 v4, v4, v36, v0 bitop3:0xf6
    v_pk_add_f32 v[32:33], v[32:33], v[36:37]
    v_pk_add_f32 v[34:35], v[34:35], v[38:39]
    s_waitcnt vmcnt(11)
    v_bitop3_b32 v4, v4, v40, v0 bitop3:0xf6
    v_pk_add_f32 v[32:33], v[32:33], v[40:41]
    v_pk_add_f32 v[34:35], v[34:35], v[42:43]
    s_waitcnt vmcnt(10)
    v_bitop3_b32 v4, v4, v44, v0 bitop3:0xf6
    v_pk_add_f32 v[32:33], v[32:33], v[44:45]
    v_pk_add_f32 v[34:35], v[34:35], v[46:47]
    s_waitcnt vmcnt(9)
    v_bitop3_b32 v4, v4, v48, v0 bitop3:0xf6
    v_pk_add_f32 v[32:33], v[32:33], v[48:49]
    v_pk_add_f32 v[34:35], v[34:35], v[50:51]
    s_waitcnt vmcnt(8)
    v_bitop3_b32 v4, v4, v52, v0 bitop3:0xf6
    v_pk_add_f32 v[32:33], v[32:33], v[52:53]
    v_pk_add_f32 v[34:35], v[34:35], v[54:55]
    s_waitcnt vmcnt(7)
    v_bitop3_b32 v4, v4, v56, v0 bitop3:0xf6
    v_and_b32 v4, 0xff, v4
    v_cmp_ne_u32 vcc, 0, v4
    v_pk_add_f32 v[32:33], v[32:33], v[56:57]
    v_pk_add_f32 v[34:35], v[34:35], v[58:59]
    s_cbranch_vccz L_e3a
    buffer_load_dwordx4 v[32:35], v5, s[8:11], s62 offen sc1
    buffer_load_dwordx4 v[36:39], v5, s[8:11], s63 offen sc1
    buffer_load_dwordx4 v[40:43], v5, s[8:11], s64 offen sc1
    buffer_load_dwordx4 v[44:47], v5, s[8:11], s65 offen sc1
    buffer_load_dwordx4 v[48:51], v5, s[8:11], s66 offen sc1
    buffer_load_dwordx4 v[52:55], v5, s[8:11], s67 offen sc1
    buffer_load_dwordx4 v[56:59], v5, s[8:11], s68 offen sc1
    s_waitcnt vmcnt(13)
    v_xor_b32 v4, v0, v64
    s_waitcnt vmcnt(12)
    v_bitop3_b32 v4, v4, v68, v0 bitop3:0xf6
    v_pk_add_f32 v[64:65], v[64:65], v[68:69]
    v_pk_add_f32 v[66:67], v[66:67], v[70:71]
    s_waitcnt vmcnt(11)
    v_bitop3_b32 v4, v4, v72, v0 bitop3:0xf6
    v_pk_add_f32 v[64:65], v[64:65], v[72:73]
    v_pk_add_f32 v[66:67], v[66:67], v[74:75]
    s_waitcnt vmcnt(10)
    v_bitop3_b32 v4, v4, v76, v0 bitop3:0xf6
    v_pk_add_f32 v[64:65], v[64:65], v[76:77]
    v_pk_add_f32 v[66:67], v[66:67], v[78:79]
    s_waitcnt vmcnt(9)
    v_bitop3_b32 v4, v4, v80, v0 bitop3:0xf6
    v_pk_add_f32 v[64:65], v[64:65], v[80:81]
    v_pk_add_f32 v[66:67], v[66:67], v[82:83]
    s_waitcnt vmcnt(8)
    v_bitop3_b32 v4, v4, v84, v0 bitop3:0xf6
    v_pk_add_f32 v[64:65], v[64:65], v[84:85]
    v_pk_add_f32 v[66:67], v[66:67], v[86:87]
    s_waitcnt vmcnt(7)
    v_bitop3_b32 v4, v4, v88, v0 bitop3:0xf6
    v_and_b32 v4, 0xff, v4
    v_cmp_ne_u32 vcc, 0, v4
    v_pk_add_f32 v[64:65], v[64:65], v[88:89]
    v_pk_add_f32 v[66:67], v[66:67], v[90:91]
    s_cbranch_vccz L_e3b
    s_add_u32 s60, s60, 1
    s_cmp_lt_u32 s60, 0x200000
    s_cbranch_scc1 L_e3p
    s_branch L_exit
L_e3a:
    s_nop 0
    v_permlane32_swap_b32 v32, v33
    v_permlane32_swap_b32 v34, v35
    v_add_f32 v32, v32, v33
    v_add_f32 v34, v34, v35
    s_nop 1
    v_permlane16_swap_b32 v32, v34
    v_add_f32 v32, v32, v34
    s_nop 1
    v_add_f32_dpp v32, v32, v32 row_ror:8 row_mask:0xf bank_mask:0xf
    s_mov_b32 exec_lo, 0x00ff00ff
    s_mov_b32 exec_hi, 0x00ff00ff
    v_fmac_f32 v226, v225, v32
    v_cvt_pk_bf16_f32 v226, v226, v226
    buffer_store_short v226, v230, s[44:47], 0 offen
    s_endpgm
L_e3b:
    s_nop 0
    v_permlane32_swap_b32 v64, v65
    v_permlane32_swap_b32 v66, v67
    v_add_f32 v64, v64, v65
    v_add_f32 v66, v66, v67
    s_nop 1
    v_permlane16_swap_b32 v64, v66
    v_add_f32 v64, v64, v66
    s_nop 1
    v_add_f32_dpp v64, v64, v64 row_ror:8 row_mask:0xf bank_mask:0xf
    s_mov_b32 exec_lo, 0x00ff00ff
    s_mov_b32 exec_hi, 0x00ff00ff
    v_fmac_f32 v226, v225, v64
    v_cvt_pk_bf16_f32 v226, v226, v226
    buffer_store_short v226, v230, s[44:47], 0 offen
L_e3z:
    s_endpgm
L_E1:
L_p8_26:
    buffer_load_dwordx4 v[100:103], v8, s[8:11], s62 offen offset:0 sc1
    buffer_load_dwordx4 v[104:107], v8, s[8:11], s62 offen offset:1024 sc1
    buffer_load_dwordx4 v[108:111], v8, s[8:11], s62 offen offset:2048 sc1
    buffer_load_dwordx4 v[112:115], v8, s[8:11], s62 offen offset:3072 sc1
    buffer_load_dwordx4 v[116:119], v8, s[8:11], s63 offen offset:0 sc1
    buffer_load_dwordx4 v[120:123], v8, s[8:11], s63 offen offset:1024 sc1
    buffer_load_dwordx4 v[124:127], v8, s[8:11], s63 offen offset:2048 sc1
    buffer_load_dwordx4 v[128:131], v8, s[8:11], s63 offen offset:3072 sc1
    s_waitcnt vmcnt(7)
    v_xor_b32 v4, v0, v100
    s_waitcnt vmcnt(6)
    v_bitop3_b32 v4, v4, v104, v0 bitop3:0xf6
    v_pk_add_f32 v[100:101], v[100:101], v[104:105]
    v_pk_add_f32 v[102:103], v[102:103], v[106:107]
    s_waitcnt vmcnt(5)
    v_bitop3_b32 v4, v4, v108, v0 bitop3:0xf6
    v_pk_add_f32 v[100:101], v[100:101], v[108:109]
    v_pk_add_f32 v[102:103], v[102:103], v[110:111]
    s_waitcnt vmcnt(4)
    v_bitop3_b32 v4, v4, v112, v0 bitop3:0xf6
    v_pk_add_f32 v[100:101], v[100:101], v[112:113]
    v_pk_add_f32 v[102:103], v[102:103], v[114:115]
    s_waitcnt vmcnt(3)
    v_bitop3_b32 v4, v4, v116, v0 bitop3:0xf6
    v_pk_add_f32 v[100:101], v[100:101], v[116:117]
    v_pk_add_f32 v[102:103], v[102:103], v[118:119]
    s_waitcnt vmcnt(2)
    v_bitop3_b32 v4, v4, v120, v0 bitop3:0xf6
    v_pk_add_f32 v[100:101], v[100:101], v[120:121]
    v_pk_add_f32 v[102:103], v[102:103], v[122:123]
    s_waitcnt vmcnt(1)
    v_bitop3_b32 v4, v4, v124, v0 bitop3:0xf6
    v_pk_add_f32 v[100:101], v[100:101], v[124:125]
    v_pk_add_f32 v[102:103], v[102:103], v[126:127]
    s_waitcnt vmcnt(0)
    v_bitop3_b32 v4, v4, v128, v0 bitop3:0xf6
    v_and_b32 v4, 0xff, v4
    v_cmp_ne_u32 vcc, 0, v4
    v_pk_add_f32 v[100:101], v[100:101], v[128:129]
    v_pk_add_f32 v[102:103], v[102:103], v[130:131]
    s_cbranch_vccz L_p8_26_ok
    s_add_u32 s60, s60, 1
    s_cmp_lt_u32 s60, 0x200000
    s_cbranch_scc1 L_p8_26
    s_branch L_exit
L_p8_26_ok:
    v_cvt_pk_bf16_f32 v24, v100, v101
    v_cvt_pk_bf16_f32 v25, v102, v103
    ds_write_b64 v10, v[24:25] offset:14336
    s_waitcnt lgkmcnt(0)
    s_barrier
    ds_read_b128 v[160:163], v11 offset:14336
    ds_read_b128 v[164:167], v11 offset:14400
    ds_read_b128 v[168:171], v11 offset:14464
    ds_read_b128 v[172:175], v11 offset:14528
    ds_read_b128 v[176:179], v11 offset:14592
    ds_read_b128 v[180:183], v11 offset:14656
    ds_read_b128 v[184:187], v11 offset:14720
    ds_read_b128 v[188:191], v11 offset:14784
    s_waitcnt lgkmcnt(7)
    v_mfma_f32_16x16x32_bf16 v[16:19], v[160:163], v[64:67], 0
    s_waitcnt lgkmcnt(6)
    v_mfma_f32_16x16x32_bf16 v[16:19], v[164:167], v[68:71], v[16:19]
    s_waitcnt lgkmcnt(5)
    v_mfma_f32_16x16x32_bf16 v[16:19], v[168:171], v[72:75], v[16:19]
    s_waitcnt lgkmcnt(4)
    v_mfma_f32_16x16x32_bf16 v[16:19], v[172:175], v[76:79], v[16:19]
    s_waitcnt lgkmcnt(3)
    v_mfma_f32_16x16x32_bf16 v[16:19], v[176:179], v[80:83], v[16:19]
    s_waitcnt lgkmcnt(2)
    v_mfma_f32_16x16x32_bf16 v[16:19], v[180:183], v[84:87], v[16:19]
    s_waitcnt lgkmcnt(1)
    v_mfma_f32_16x16x32_bf16 v[16:19], v[184:187], v[88:91], v[16:19]
    s_waitcnt lgkmcnt(0)
    v_mfma_f32_16x16x32_bf16 v[16:19], v[188:191], v[92:95], v[16:19]
    s_mov_b64 exec, 0xffff
    s_nop 6
    v_pk_add_f32 v[16:17], v[16:17], v[18:19]
    v_add_f32 v16, v16, v17
    v_and_or_b32 v16, v16, s50, v2
    buffer_store_dword v16, v12, s[8:11], s56 offen sc1
    s_endpgm
L_E2:
    s_mov_b64 s[40:41], s[28:29]
    s_mov_b32 s42, 1605632
    s_lshl_b32 s52, s13, 6
    s_mov_b32 s51, 3584
    s_mov_b32 s57, 2
    s_mov_b32 s58, 7
    v_lshrrev_b32 v6, s57, v3
    v_mul_lo_u32 v17, v6, s51
    v_lshlrev_b32 v7, s57, v6
    v_sub_u32 v7, v3, v7
    s_cmp_eq_u32 s57, 3
    s_cselect_b32 s59, 2, 0
    v_and_b32 v6, s59, v6
    v_xor_b32 v7, v7, v6
    v_lshl_add_u32 v17, v7, 4, v17
    s_lshl_b32 s59, s59, 5
    s_sub_u32 s53, 6, s57
    s_lshl_b32 s53, s51, s53
    s_mul_i32 s54, s12, s58
    s_mul_i32 s55, s54, s53
    s_add_u32 s52, s52, s55
    s_lshl_b32 s54, s54, 10
    s_add_u32 m0, s54, 30720
    s_mov_b32 s55, s58
L_dma_27:
    buffer_load_dwordx4 v17, s[40:43], s52 offen  lds
    s_add_u32 s52, s52, s53
    s_add_u32 m0, m0, 1024
    v_xor_b32 v17, s59, v17
    s_sub_u32 s55, s55, 1
    s_cmp_lg_u32 s55, 0
    s_cbranch_scc1 L_dma_27
    s_mov_b64 s[40:41], s[30:31]
    s_mov_b32 s42, 1605632
    s_lshl_b32 s52, s13, 6
    s_mov_b32 s51, 3584
    s_mov_b32 s57, 2
    s_mov_b32 s58, 7
    v_lshrrev_b32 v6, s57, v3
    v_mul_lo_u32 v17, v6, s51
    v_lshlrev_b32 v7, s57, v6
    v_sub_u32 v7, v3, v7
    s_cmp_eq_u32 s57, 3
    s_cselect_b32 s59, 2, 0
    v_and_b32 v6, s59, v6
    v_xor_b32 v7, v7, v6
    v_lshl_add_u32 v17, v7, 4, v17
    s_lshl_b32 s59, s59, 5
    s_sub_u32 s53, 6, s57
    s_lshl_b32 s53, s51, s53
    s_mul_i32 s54, s12, s58
    s_mul_i32 s55, s54, s53
    s_add_u32 s52, s52, s55
    s_lshl_b32 s54, s54, 10
    s_add_u32 m0, s54, 59424
    s_mov_b32 s55, s58
L_dma_28:
    buffer_load_dwordx4 v17, s[40:43], s52 offen  lds
    s_add_u32 s52, s52, s53
    s_add_u32 m0, m0, 1024
    v_xor_b32 v17, s59, v17
    s_sub_u32 s55, s55, 1
    s_cmp_lg_u32 s55, 0
    s_cbranch_scc1 L_dma_28
    s_mov_b64 s[40:41], s[32:33]
    s_mov_b32 s42, 1605632
    s_mul_i32 s52, s13, 28672
    s_mov_b32 s51, 64
    s_mov_b32 s57, 2
    s_mov_b32 s58, 7
    v_lshrrev_b32 v6, s57, v3
    v_mul_lo_u32 v17, v6, s51
    v_lshlrev_b32 v7, s57, v6
    v_sub_u32 v7, v3, v7
    s_cmp_eq_u32 s57, 3
    s_cselect_b32 s59, 2, 0
    v_and_b32 v6, s59, v6
    v_xor_b32 v7, v7, v6
    v_lshl_add_u32 v17, v7, 4, v17
    s_lshl_b32 s59, s59, 5
    s_sub_u32 s53, 6, s57
    s_lshl_b32 s53, s51, s53
    s_mul_i32 s54, s12, s58
    s_mul_i32 s55, s54, s53
    s_add_u32 s52, s52, s55
    s_lshl_b32 s54, s54, 10
    s_add_u32 m0, s54, 88128
    s_mov_b32 s55, s58
L_dma_29:
    buffer_load_dwordx4 v17, s[40:43], s52 offen  lds
    s_add_u32 s52, s52, s53
    s_add_u32 m0, m0, 1024
    v_xor_b32 v17, s59, v17
    s_sub_u32 s55, s55, 1
    s_cmp_lg_u32 s55, 0
    s_cbranch_scc1 L_dma_29
    v_lshrrev_b32 v4, 4, v3
    v_bfe_u32 v5, v3, 2, 2
    v_lshl_add_u32 v4, v4, 3, v5
    v_lshlrev_b32 v6, 6, v4
    v_and_b32 v5, 1, v3
    v_lshl_add_u32 v6, v5, 3, v6
    v_bfe_u32 v5, v3, 1, 1
    v_mul_u32_u24 v5, 28704, v5
    v_add_u32 v6, v6, v5
    s_lshl_b32 s53, s12, 4
    s_add_u32 s53, s53, 30720
    v_add_u32 v6, s53, v6
    s_waitcnt vmcnt(7)
    s_barrier
    ds_read_b64_tr_b16 v[64:65], v6 offset:0
    ds_read_b64_tr_b16 v[66:67], v6 offset:256
    ds_read_b64_tr_b16 v[68:69], v6 offset:2048
    ds_read_b64_tr_b16 v[70:71], v6 offset:2304
    ds_read_b64_tr_b16 v[72:73], v6 offset:4096
    ds_read_b64_tr_b16 v[74:75], v6 offset:4352
    ds_read_b64_tr_b16 v[76:77], v6 offset:6144
    ds_read_b64_tr_b16 v[78:79], v6 offset:6400
    ds_read_b64_tr_b16 v[80:81], v6 offset:8192
    ds_read_b64_tr_b16 v[82:83], v6 offset:8448
    ds_read_b64_tr_b16 v[84:85], v6 offset:10240
    ds_read_b64_tr_b16 v[86:87], v6 offset:10496
    ds_read_b64_tr_b16 v[88:89], v6 offset:12288
    ds_read_b64_tr_b16 v[90:91], v6 offset:12544
    ds_read_b64_tr_b16 v[92:93], v6 offset:14336
    ds_read_b64_tr_b16 v[94:95], v6 offset:14592
    ds_read_b64_tr_b16 v[96:97], v6 offset:16384
    ds_read_b64_tr_b16 v[98:99], v6 offset:16640
    ds_read_b64_tr_b16 v[100:101], v6 offset:18432
    ds_read_b64_tr_b16 v[102:103], v6 offset:18688
    ds_read_b64_tr_b16 v[104:105], v6 offset:20480
    ds_read_b64_tr_b16 v[106:107], v6 offset:20736
    ds_read_b64_tr_b16 v[108:109], v6 offset:22528
    ds_read_b64_tr_b16 v[110:111], v6 offset:22784
    ds_read_b64_tr_b16 v[112:113], v6 offset:24576
    ds_read_b64_tr_b16 v[114:115], v6 offset:24832
    ds_read_b64_tr_b16 v[116:117], v6 offset:26624
    ds_read_b64_tr_b16 v[118:119], v6 offset:26880
    v_mul_u32_u24 v7, 896, v4
    v_and_b32 v5, 3, v3
    v_lshl_add_u32 v7, v5, 3, v7
    s_lshl_b32 s53, s12, 8
    s_add_u32 s53, s53, 88128
    v_add_u32 v7, s53, v7
    v_lshrrev_b32 v14, 4, v3
    v_lshlrev_b32 v14, 4, v14
    v_and_b32 v13, 1, v3
    v_mul_u32_u24 v13, 960, v13
    v_add_u32 v13, v13, v14
    s_waitcnt lgkmcnt(0)
    ds_read_b128 v[160:163], v13 offset:28672
    ds_read_b128 v[164:167], v13 offset:28736
    ds_read_b128 v[168:171], v13 offset:28800
    ds_read_b128 v[172:175], v13 offset:28864
    ds_read_b128 v[176:179], v13 offset:28928
    ds_read_b128 v[180:183], v13 offset:28992
    ds_read_b128 v[184:187], v13 offset:29056
    ds_read_b128 v[188:191], v13 offset:29120
    ds_read_b128 v[192:195], v13 offset:29184
    ds_read_b128 v[196:199], v13 offset:29248
    ds_read_b128 v[200:203], v13 offset:29312
    ds_read_b128 v[204:207], v13 offset:29376
    ds_read_b128 v[208:211], v13 offset:29440
    ds_read_b128 v[212:215], v13 offset:29504
    s_waitcnt lgkmcnt(13)
    v_mfma_f32_16x16x32_bf16 v[156:159], v[160:163], v[64:67], 0
    s_waitcnt lgkmcnt(12)
    v_mfma_f32_16x16x32_bf16 v[156:159], v[164:167], v[68:71], v[156:159]
    s_waitcnt lgkmcnt(11)
    v_mfma_f32_16x16x32_bf16 v[156:159], v[168:171], v[72:75], v[156:159]
    s_waitcnt lgkmcnt(10)
    v_mfma_f32_16x16x32_bf16 v[156:159], v[172:175], v[76:79], v[156:159]
    s_waitcnt lgkmcnt(9)
    v_mfma_f32_16x16x32_bf16 v[156:159], v[176:179], v[80:83], v[156:159]
    s_waitcnt lgkmcnt(8)
    v_mfma_f32_16x16x32_bf16 v[156:159], v[180:183], v[84:87], v[156:159]
    s_waitcnt lgkmcnt(7)
    v_mfma_f32_16x16x32_bf16 v[156:159], v[184:187], v[88:91], v[156:159]
    s_waitcnt lgkmcnt(6)
    v_mfma_f32_16x16x32_bf16 v[156:159], v[188:191], v[92:95], v[156:159]
    s_waitcnt lgkmcnt(5)
    v_mfma_f32_16x16x32_bf16 v[156:159], v[192:195], v[96:99], v[156:159]
    s_waitcnt lgkmcnt(4)
    v_mfma_f32_16x16x32_bf16 v[156:159], v[196:199], v[100:103], v[156:159]
    s_waitcnt lgkmcnt(3)
    v_mfma_f32_16x16x32_bf16 v[156:159], v[200:203], v[104:107], v[156:159]
    s_waitcnt lgkmcnt(2)
    v_mfma_f32_16x16x32_bf16 v[156:159], v[204:207], v[108:111], v[156:159]
    s_waitcnt lgkmcnt(1)
    v_mfma_f32_16x16x32_bf16 v[156:159], v[208:211], v[112:115], v[156:159]
    s_waitcnt lgkmcnt(0)
    v_mfma_f32_16x16x32_bf16 v[156:159], v[212:215], v[116:119], v[156:159]
    s_waitcnt vmcnt(0)
    s_barrier
    ds_read_b64_tr_b16 v[120:121], v7 offset:0
    ds_read_b64_tr_b16 v[122:123], v7 offset:3584
    ds_read_b64_tr_b16 v[124:125], v7 offset:32
    ds_read_b64_tr_b16 v[126:127], v7 offset:3616
    ds_read_b64_tr_b16 v[128:129], v7 offset:64
    ds_read_b64_tr_b16 v[130:131], v7 offset:3648
    ds_read_b64_tr_b16 v[132:133], v7 offset:96
    ds_read_b64_tr_b16 v[134:135], v7 offset:3680
    ds_read_b64_tr_b16 v[136:137], v7 offset:128
    ds_read_b64_tr_b16 v[138:139], v7 offset:3712
    ds_read_b64_tr_b16 v[140:141], v7 offset:160
    ds_read_b64_tr_b16 v[142:143], v7 offset:3744
    ds_read_b64_tr_b16 v[144:145], v7 offset:192
    ds_read_b64_tr_b16 v[146:147], v7 offset:3776
    ds_read_b64_tr_b16 v[148:149], v7 offset:224
    ds_read_b64_tr_b16 v[150:151], v7 offset:3808
    v_and_b32 v13, 3, v3
    v_mul_u32_u24 v13, 960, v13
    v_add_u32 v13, v13, v14
    s_mul_i32 s55, s12, 960
    v_add_u32 v10, s55, v10
    v_add_u32 v11, s55, v11
    s_lshl_b32 s55, s12, 11
    v_add_u32 v12, s55, v8
    s_lshl_b32 s55, s12, 4
    v_lshl_add_u32 v15, v3, 1, s55
    v_bfe_u32 v1, v9, 4, 1
    v_lshlrev_b32 v1, 7, v1
    v_xor_b32 v1, s6, v1
    s_mul_i32 s53, s12, 7168
    s_add_u32 s53, s53, 0x10000
    s_add_u32 s54, s53, 3584
    v_lshlrev_b32 v5, 2, v3
    s_mul_i32 s56, s13, 1792
    s_lshl_b32 s55, s12, 9
    s_add_u32 s56, s56, s55
    s_add_u32 s56, s56, 0x17000
    s_mov_b32 s64, 0xffff0000
    s_mov_b32 s65, 0
    s_mov_b32 s66, 0
    s_mov_b32 s67, 0xffff
    s_mov_b32 s68, 0
    s_mov_b32 s69, 0xffff0000
    s_mov_b32 s59, 0xbfb8aa3b
    s_mul_i32 s52, s4, 0x18000
    s_add_u32 s52, s52, 0x40000
    v_and_b32 v6, 31, v3
    v_lshlrev_b32 v6, 10, v6
    s_mov_b32 exec_hi, 0
L_p8_30:
    buffer_load_dword v18, v6, s[8:11], s52 offen sc1
    s_waitcnt vmcnt(0)
    v_xor_b32 v4, s6, v18
    v_and_b32 v4, 0xff, v4
    v_cmp_ne_u32 vcc, 0, v4
    s_cbranch_vccz L_p8_30_ok
    s_sleep 1
    s_add_u32 s60, s60, 1
    s_cmp_lt_u32 s60, 0x200000
    s_cbranch_scc1 L_p8_30
    s_branch L_exit
L_p8_30_ok:
    s_mov_b32 exec_hi, -1
L_p8_31:
    buffer_load_dwordx4 v[24:27], v8, s[8:11], s53 offen offset:0 sc1
    buffer_load_dwordx4 v[28:31], v9, s[8:11], s53 offen offset:0 sc1
    buffer_load_dwordx4 v[32:35], v8, s[8:11], s53 offen offset:1792 sc1
    buffer_load_dwordx4 v[36:39], v9, s[8:11], s53 offen offset:1792 sc1
    buffer_load_dwordx4 v[40:43], v8, s[8:11], s54 offen offset:0 sc1
    buffer_load_dwordx4 v[44:47], v9, s[8:11], s54 offen offset:0 sc1
    buffer_load_dwordx4 v[48:51], v8, s[8:11], s54 offen offset:1792 sc1
    buffer_load_dwordx4 v[52:55], v9, s[8:11], s54 offen offset:1792 sc1
    s_waitcnt vmcnt(7)
    v_xor_b32 v4, v0, v24
    s_waitcnt vmcnt(6)
    v_bitop3_b32 v4, v4, v28, v1 bitop3:0xf6
    s_waitcnt vmcnt(5)
    v_bitop3_b32 v4, v4, v32, v0 bitop3:0xf6
    v_pk_add_f32 v[24:25], v[24:25], v[32:33]
    v_pk_add_f32 v[26:27], v[26:27], v[34:35]
    s_waitcnt vmcnt(4)
    v_bitop3_b32 v4, v4, v36, v1 bitop3:0xf6
    v_pk_add_f32 v[28:29], v[28:29], v[36:37]
    v_pk_add_f32 v[30:31], v[30:31], v[38:39]
    s_waitcnt vmcnt(3)
    v_bitop3_b32 v4, v4, v40, v0 bitop3:0xf6
    v_pk_add_f32 v[24:25], v[24:25], v[40:41]
    v_pk_add_f32 v[26:27], v[26:27], v[42:43]
    s_waitcnt vmcnt(2)
    v_bitop3_b32 v4, v4, v44, v1 bitop3:0xf6
    v_pk_add_f32 v[28:29], v[28:29], v[44:45]
    v_pk_add_f32 v[30:31], v[30:31], v[46:47]
    s_waitcnt vmcnt(1)
    v_bitop3_b32 v4, v4, v48, v0 bitop3:0xf6
    v_pk_add_f32 v[24:25], v[24:25], v[48:49]
    v_pk_add_f32 v[26:27], v[26:27], v[50:51]
    s_waitcnt vmcnt(0)
    v_bitop3_b32 v4, v4, v52, v1 bitop3:0xf6
    v_and_b32 v4, 0xff, v4
    v_cmp_ne_u32 vcc, 0, v4
    v_pk_add_f32 v[28:29], v[28:29], v[52:53]
    v_pk_add_f32 v[30:31], v[30:31], v[54:55]
    s_cbranch_vccz L_p8_31_ok
    s_add_u32 s60, s60, 1
    s_cmp_lt_u32 s60, 0x200000
    s_cbranch_scc1 L_p8_31
    s_branch L_exit
L_p8_31_ok:
    v_pk_fma_f32 v[32:33], v[24:25], v[240:241], v[232:233]
    v_pk_fma_f32 v[34:35], v[26:27], v[242:243], v[234:235]
    v_pk_fma_f32 v[36:37], v[28:29], v[244:245], v[236:237]
    v_pk_fma_f32 v[38:39], v[30:31], v[246:247], v[238:239]
    v_cvt_pk_bf16_f32 v20, v32, v33
    v_cvt_pk_bf16_f32 v21, v34, v35
    v_cvt_pk_bf16_f32 v22, v36, v37
    v_cvt_pk_bf16_f32 v23, v38, v39
    ds_write_b64 v10, v[20:21] offset:24576
    ds_write_b64 v11, v[22:23] offset:24576
    ds_write_b128 v12, v[24:27] offset:14336
    ds_write_b128 v12, v[28:31] offset:15360
    s_waitcnt lgkmcnt(0)
    s_barrier
    ds_read_b128 v[24:27], v8 offset:14336
    ds_read_b128 v[28:31], v8 offset:15360
    ds_read_b128 v[32:35], v8 offset:16384
    ds_read_b128 v[36:39], v8 offset:17408
    ds_read_b128 v[40:43], v8 offset:18432
    ds_read_b128 v[44:47], v8 offset:19456
    ds_read_b128 v[48:51], v8 offset:20480
    ds_read_b128 v[52:55], v8 offset:21504
    ds_read_b128 v[160:163], v13 offset:24576
    ds_read_b128 v[164:167], v13 offset:24640
    ds_read_b128 v[168:171], v13 offset:24704
    ds_read_b128 v[172:175], v13 offset:24768
    ds_read_b128 v[176:179], v13 offset:24832
    ds_read_b128 v[180:183], v13 offset:24896
    s_waitcnt lgkmcnt(10)
    v_pk_add_f32 v[24:25], v[24:25], v[32:33]
    v_pk_add_f32 v[26:27], v[26:27], v[34:35]
    v_pk_add_f32 v[28:29], v[28:29], v[36:37]
    v_pk_add_f32 v[30:31], v[30:31], v[38:39]
    s_waitcnt lgkmcnt(6)
    ds_read_b128 v[184:187], v13 offset:24960
    ds_read_b128 v[188:191], v13 offset:25024
    ds_read_b128 v[192:195], v13 offset:25088
    ds_read_b128 v[196:199], v13 offset:25152
    ds_read_b128 v[200:203], v13 offset:25216
    ds_read_b128 v[204:207], v13 offset:25280
    ds_read_b128 v[208:211], v13 offset:25344
    ds_read_b128 v[212:215], v13 offset:25408
    v_pk_add_f32 v[40:41], v[40:41], v[48:49]
    v_pk_add_f32 v[42:43], v[42:43], v[50:51]
    v_pk_add_f32 v[44:45], v[44:45], v[52:53]
    v_pk_add_f32 v[46:47], v[46:47], v[54:55]
    v_pk_add_f32 v[24:25], v[24:25], v[40:41]
    v_pk_add_f32 v[26:27], v[26:27], v[42:43]
    v_pk_add_f32 v[28:29], v[28:29], v[44:45]
    v_pk_add_f32 v[30:31], v[30:31], v[46:47]
    v_pk_fma_f32 v[24:25], v[24:25], v[224:225], v[248:249]
    v_pk_fma_f32 v[26:27], v[26:27], v[226:227], v[250:251]
    v_pk_fma_f32 v[28:29], v[28:29], v[228:229], v[252:253]
    v_pk_fma_f32 v[30:31], v[30:31], v[230:231], v[254:255]
    v_pk_add_f32 v[40:41], v[24:25], v[26:27]
    v_pk_mul_f32 v[42:43], v[24:25], v[24:25]
    v_pk_add_f32 v[44:45], v[28:29], v[30:31]
    v_pk_fma_f32 v[42:43], v[26:27], v[26:27], v[42:43]
    v_pk_add_f32 v[40:41], v[40:41], v[44:45]
    v_pk_fma_f32 v[42:43], v[28:29], v[28:29], v[42:43]
    v_add_f32 v40, v40, v41
    v_pk_fma_f32 v[42:43], v[30:31], v[30:31], v[42:43]
    s_waitcnt lgkmcnt(0)
    v_add_f32 v42, v42, v43
    v_mfma_f32_16x16x32_bf16 v[16:19], v[160:163], v[64:67], 0
    v_mfma_f32_16x16x32_bf16 v[16:19], v[164:167], v[68:71], v[16:19]
    v_permlane32_swap_b32 v40, v42
    v_add_f32 v40, v40, v42
    v_mov_b32 v42, v40
    v_mfma_f32_16x16x32_bf16 v[16:19], v[168:171], v[72:75], v[16:19]
    v_mfma_f32_16x16x32_bf16 v[16:19], v[172:175], v[76:79], v[16:19]
    v_permlane16_swap_b32 v40, v42
    v_add_f32 v40, v40, v42
    v_mfma_f32_16x16x32_bf16 v[16:19], v[176:179], v[80:83], v[16:19]
    v_mfma_f32_16x16x32_bf16 v[16:19], v[180:183], v[84:87], v[16:19]
    v_add_f32_dpp v40, v40, v40 row_ror:8 row_mask:0xf bank_mask:0xf
    v_mfma_f32_16x16x32_bf16 v[16:19], v[184:187], v[88:91], v[16:19]
    s_nop 0
    v_add_f32_dpp v40, v40, v40 row_ror:4 row_mask:0xf bank_mask:0xf
    v_mfma_f32_16x16x32_bf16 v[16:19], v[188:191], v[92:95], v[16:19]
    s_nop 0
    v_add_f32_dpp v40, v40, v40 row_ror:2 row_mask:0xf bank_mask:0xf
    v_mfma_f32_16x16x32_bf16 v[16:19], v[192:195], v[96:99], v[16:19]
    s_nop 0
    v_add_f32_dpp v40, v40, v40 row_ror:1 row_mask:0xf bank_mask:0xf
    v_mfma_f32_16x16x32_bf16 v[16:19], v[196:199], v[100:103], v[16:19]
    v_mul_f32 v40, 0x3b124925, v40
    v_mov_b32 v42, v40
    v_mfma_f32_16x16x32_bf16 v[16:19], v[200:203], v[104:107], v[16:19]
    v_mfma_f32_16x16x32_bf16 v[16:19], v[204:207], v[108:111], v[16:19]
    v_permlane32_swap_b32 v40, v42
    v_fma_f32 v42, -v40, v40, v42
    v_max_f32 v42, 0, v42
    v_mfma_f32_16x16x32_bf16 v[16:19], v[208:211], v[112:115], v[16:19]
    v_add_f32 v42, 0x3727c5ac, v42
    v_rsq_f32 v42, v42
    v_mfma_f32_16x16x32_bf16 v[16:19], v[212:215], v[116:119], v[16:19]
    v_mul_f32 v40, v40, v156
    v_fma_f32 v157, -v40, v42, v157
    s_nop 5
    v_pk_add_f32 v[16:17], v[16:17], v[18:19]
    v_add_f32 v16, v16, v17
    v_fma_f32 v16, v42, v16, v157
    v_mul_f32 v20, s59, v16
    v_exp_f32 v20, v20
    v_mul_f32_dpp v21, v16, v16 row_ror:8 row_mask:0xf bank_mask:0xf
    v_add_f32 v20, 1.0, v20
    v_rcp_f32 v20, v20
    s_mov_b64 exec, 0xff
    v_mul_f32 v20, v20, v21
    v_cvt_pk_bf16_f32 v20, v20, v20
    ds_write_b16 v15, v20 offset:22528
    s_mov_b64 exec, -1
    s_waitcnt lgkmcnt(0)
    s_barrier
    ds_read_b128 v[20:23], v14 offset:22528
    s_cmp_eq_u32 s12, 3
    s_waitcnt lgkmcnt(0)
    v_mfma_f32_16x16x32_bf16 v[160:163], v[20:23], v[120:123], 0
    v_mfma_f32_16x16x32_bf16 v[164:167], v[20:23], v[124:127], 0
    v_mfma_f32_16x16x32_bf16 v[168:171], v[20:23], v[128:131], 0
    v_mfma_f32_16x16x32_bf16 v[172:175], v[20:23], v[132:135], 0
    v_mfma_f32_16x16x32_bf16 v[176:179], v[20:23], v[136:139], 0
    v_mfma_f32_16x16x32_bf16 v[180:183], v[20:23], v[140:143], 0
    v_mfma_f32_16x16x32_bf16 v[184:187], v[20:23], v[144:147], 0
    v_mfma_f32_16x16x32_bf16 v[188:191], v[20:23], v[148:151], 0
    s_nop 1
    v_cndmask_b32 v24, v160, v164, s[64:65]
    v_cndmask_b32 v24, v24, v168, s[66:67]
    v_cndmask_b32 v24, v24, v172, s[68:69]
    v_and_or_b32 v24, v24, s50, v2
    buffer_store_dword v24, v5, s[8:11], s56 offen offset:0 sc1
    s_cbranch_scc1 L_exit
    v_cndmask_b32 v25, v176, v180, s[64:65]
    v_cndmask_b32 v25, v25, v184, s[66:67]
    v_cndmask_b32 v25, v25, v188, s[68:69]
    v_and_or_b32 v25, v25, s50, v2
    buffer_store_dword v25, v5, s[8:11], s56 offen offset:256 sc1
L_exit:
L_end:
s_endpgm
.section .rodata,"a"
.p2align 6
.amdhsa_kernel adaLN_cond__gqa_block_cached__swiglu_ffn__decode_kernel
  .amdhsa_next_free_vgpr 256
  .amdhsa_next_free_sgpr 102
  .amdhsa_accum_offset 256
  .amdhsa_group_segment_fixed_size 0
  .amdhsa_kernarg_size 112
  .amdhsa_user_sgpr_count 2
  .amdhsa_user_sgpr_kernarg_segment_ptr 1
  .amdhsa_system_sgpr_workgroup_id_x 1
.end_amdhsa_kernel
```
